```python
import torch

def _softmax(x, axis=-1):
    return torch.softmax(x, dim=axis)
def _gelu(x):
    return torch.nn.functional.gelu(x, approximate="tanh")
def _silu(x):
    return torch.nn.functional.silu(x)
def _sigmoid(x):
    return torch.sigmoid(x)
def _layernorm(x, axis=-1, eps=1e-5):
    m = x.mean(dim=axis, keepdim=True)
    v = x.var(dim=axis, keepdim=True, unbiased=False)
    return (x - m) / torch.sqrt(v + eps)
def _scatter_add(tgt, idx, src, axis=0):
    return tgt.clone().index_add_(axis, idx, src)
def _segment_sum(src, seg, n):
    out = torch.zeros((n,) + src.shape[1:], dtype=src.dtype)
    return out.index_add_(0, seg, src)
def _pad(x, pw):
    flat = tuple(v for pair in reversed(pw) for v in pair)
    return torch.nn.functional.pad(x, flat)

kernel_name = 'recurrent_scan__mha_block_cached__geglu_ffn__decode'

def setup_inputs():

    _w = (lambda a: (lambda t: t.to(torch.bfloat16) if t.is_floating_point() else t)(torch.as_tensor(a)))
    def _A_setup():
        B, Sq, D = 2, 1, 640
        H, Sk, Dh = 32, 4096, 192
        return {
            "x": _w((lambda *s: torch.randn(*s, dtype=torch.bfloat16) * 0.05)(B, Sq, D)),
            "k_cache": _w((lambda *s: torch.randn(*s, dtype=torch.bfloat16) * 1.6)(B, H, Sk, Dh)),
            "v_cache": _w((lambda *s: torch.randn(*s, dtype=torch.bfloat16) * 0.2)(B, H, Sk, Dh)),
            "wq": _w((lambda *s: torch.randn(*s, dtype=torch.bfloat16) * 1.6)(D, H * Dh) * (D ** -0.5)),
            "wo": _w((lambda *s: torch.randn(*s, dtype=torch.bfloat16) * 0.2)(H * Dh, D) * ((H * Dh) ** -0.5)),
        }
    _A_in = _A_setup()

    def _B_setup():
        B, S, D, F = 2, 1, 640, 1536
        return {
            "x": _w((lambda *s: torch.randn(*s, dtype=torch.bfloat16) * 0.05)(B, S, D)),
            "w_gate": _w((lambda *s: torch.randn(*s, dtype=torch.bfloat16) * 0.1)(D, F)),
            "w_up": _w((lambda *s: torch.randn(*s, dtype=torch.bfloat16) * 0.1)(D, F)),
            "w_down": _w((lambda *s: torch.randn(*s, dtype=torch.bfloat16) * 0.1)(F, D)),
        }
    _B_in = _B_setup()

    return {
        "A_x": _A_in["x"],
        "A_k_cache": _A_in["k_cache"],
        "A_v_cache": _A_in["v_cache"],
        "A_wq": _A_in["wq"],
        "A_wo": _A_in["wo"],
        "B_x": _B_in["x"],
        "B_w_gate": _B_in["w_gate"],
        "B_w_up": _B_in["w_up"],
        "B_w_down": _B_in["w_down"],
    }

def reference(A_x, A_k_cache, A_v_cache, A_wq, A_wo, B_x, B_w_gate, B_w_up, B_w_down):
    def _A_ref(x, k_cache, v_cache, wq, wo):
        B, Sq, D = x.shape
        H, Dh = 32, 192
        q = (lambda x, *d: x.permute(*d))((x @ wq).reshape(B, Sq, H, Dh), 0, 2, 1, 3)
        scores = torch.einsum("bhqd,bhkd->bhqk", q, k_cache) * (Dh ** -0.5)
        p = _softmax(scores, axis=-1)
        o = torch.einsum("bhqk,bhkd->bhqd", p, v_cache)
        return (lambda x, *d: x.permute(*d))(o, 0, 2, 1, 3).reshape(B, Sq, H * Dh) @ wo

    def _B_ref(x, w_gate, w_up, w_down):
        return (_gelu(x @ w_gate) * (x @ w_up)) @ w_down

    x = A_x
    xn = _layernorm(x, axis=-1)
    s = _A_ref(xn, A_k_cache, A_v_cache, A_wq, A_wo)
    g = _silu(_B_ref(xn, B_w_gate, B_w_up, B_w_down))
    return x + s * g
```

```asm
; @launch grid=(256,1,1) block=(1024,1,1) lds=133120
.amdgcn_target "amdgcn-amd-amdhsa--gfx950"
.text
.globl recurrent_scan__mha_block_cached__geglu_ffn__decode_kernel
.p2align 8
.type recurrent_scan__mha_block_cached__geglu_ffn__decode_kernel,@function
recurrent_scan__mha_block_cached__geglu_ffn__decode_kernel:
  s_cmp_ge_u32 s2, 256
  s_cbranch_scc1 L_end
  s_load_dwordx16 s[4:19], s[0:1], 0
  s_load_dwordx8 s[20:27], s[0:1], 64
  v_lshrrev_b32 v3, 6, v0
  v_and_b32 v2, 63, v0
  s_and_b32 s84, s2, 7
  v_readfirstlane_b32 s30, v3
  s_lshr_b32 s85, s2, 3
  s_and_b32 s29, s85, 7
  s_lshr_b32 s85, s85, 3
  s_lshl_b32 s28, s84, 2
  s_add_u32 s28, s28, s85
  s_lshr_b32 s31, s29, 2
  s_lshl_b32 s96, s28, 3
  s_add_u32 s96, s96, s29
  v_lshrrev_b32 v4, 3, v2
  v_and_b32 v5, 7, v2
  v_lshlrev_b32 v5, 4, v5
  v_mul_u32_u24 v1, 384, v4
  v_add_u32 v1, v1, v5
  s_and_b32 s85, s29, 3
  s_lshr_b32 s84, s29, 2
  s_lshl_b32 s84, s84, 1
  s_mul_i32 s84, s84, 0
  s_add_u32 s85, s85, s84
  s_mul_i32 s91, s85, 393216
  s_add_u32 s91, s91, 322560
  s_mul_i32 s85, s85, 0
  s_add_u32 s85, s85, s30
  s_sub_u32 s85, s85, 1
  s_mul_i32 s76, s85, 21504
  s_and_b32 s84, s29, 1
  s_mul_i32 s84, s84, 0
  s_add_u32 s91, s91, s84
  s_add_u32 s76, s76, s91
  s_sub_u32 s76, s76, 322560
  s_nop 0
  s_cmp_eq_u32 s30, 0
  s_cselect_b32 s76, 0x7fff0000, s76
  s_lshl_b32 s84, s31, 5
  s_add_u32 s84, s84, s28
  s_lshl_b32 s97, s84, 7
  s_add_u32 s97, s97, 2031616
  s_mul_i32 s101, s84, 1572864
  s_and_b32 s95, s28, 3
  s_lshl_b32 s95, s95, 4
  s_lshr_b32 s85, s28, 2
  s_add_u32 s95, s95, s85
  s_lshl_b32 s95, s95, 2
  v_mov_b32 v104, 0
  v_lshlrev_b32 v3, 2, v2
  v_add_u32 v3, 3968, v3
  s_cmp_eq_u32 s30, 0
  s_cbranch_scc0 L_noz
  ds_write_b32 v3, v104
  v_mov_b32 v104, -1
  ds_write_b32 v3, v104 offset:12736
L_noz:
  s_waitcnt lgkmcnt(0)
  s_add_u32 s32, s6, s101
  s_addc_u32 s33, s7, 0
  s_mov_b32 s34, 1572864
  s_mov_b32 s35, 0x20000
  s_and_b32 s90, s29, 1
  s_mul_i32 s90, s90, 0
  s_sub_u32 s90, 23, s90
  s_sub_u32 s3, s30, 1
  s_cmp_ge_u32 s3, 10
  s_cbranch_scc1 L_role_hi
  s_cmp_ge_u32 s3, 2
  s_cbranch_scc1 L_role_w1
  s_mov_b32 s68, s4
  s_mov_b32 s69, s5
  s_mov_b32 s70, 2560
  s_mov_b32 s71, 0x20000
  s_mul_i32 s84, s3, 1280
  v_lshlrev_b32 v3, 2, v2
  buffer_load_dword v100, v3, s[68:71], s84 offen offset:0
  buffer_load_dword v101, v3, s[68:71], s84 offen offset:256
  buffer_load_dword v102, v3, s[68:71], s84 offen offset:512
  buffer_load_dword v103, v3, s[68:71], s84 offen offset:768
  buffer_load_dword v104, v3, s[68:71], s84 offen offset:1024
L_role_w1:
  s_mul_i32 s84, s29, 983040
  s_mul_i32 s85, s28, 384
  s_add_u32 s84, s84, s85
  s_add_u32 s40, s10, s84
  s_addc_u32 s41, s11, 0
  s_mov_b32 s42, 971136
  s_mov_b32 s43, 0x20000
  v_mul_u32_u24 v3, 12288, v4
  v_add_u32 v3, v3, v5
  s_mul_i32 s84, s3, 98304
  s_mul_i32 s85, s3, 5120
  s_add_u32 m0, s85, 20480
  s_add_u32 s86, s84, 0
  buffer_load_dwordx4 v3, s[40:43], s86 offen nt lds
  s_add_u32 m0, s85, 21504
  s_add_u32 s86, s84, 128
  buffer_load_dwordx4 v3, s[40:43], s86 offen nt lds
  s_add_u32 m0, s85, 22528
  s_add_u32 s86, s84, 256
  buffer_load_dwordx4 v3, s[40:43], s86 offen nt lds
  s_mul_i32 s84, s29, 245760
  s_mul_i32 s86, s28, 96
  s_add_u32 s84, s84, s86
  s_add_u32 s44, s16, s84
  s_addc_u32 s45, s17, 0
  s_mov_b32 s46, 242784
  s_mov_b32 s47, 0x20000
  s_add_u32 s48, s18, s84
  s_addc_u32 s49, s19, 0
  s_mov_b32 s50, 242784
  s_mov_b32 s51, 0x20000
  v_mul_u32_u24 v6, 3072, v4
  v_add_u32 v6, v6, v5
  s_mul_i32 s84, s3, 24576
  s_mov_b32 exec_lo, 0x3f3f3f3f
  s_mov_b32 exec_hi, 0x3f3f3f3f
  s_add_u32 m0, s85, 23552
  s_nop 0
  buffer_load_dwordx4 v6, s[44:47], s84 offen nt lds
  s_add_u32 m0, s85, 24576
  s_nop 0
  buffer_load_dwordx4 v6, s[48:51], s84 offen nt lds
  s_mov_b64 exec, -1
  s_barrier
  s_branch L_role_done
L_role_hi:
  s_cmp_eq_u32 s30, 0
  s_cbranch_scc0 L_noclr
  s_setprio 3
  s_mov_b32 s60, s26
  s_mov_b32 s61, s27
  s_mov_b32 s62, 2097152
  s_mov_b32 s63, 0x20000
  v_mov_b32 v120, -1
  v_mov_b32 v121, -1
  v_mov_b32 v122, -1
  v_mov_b32 v123, -1
  v_lshlrev_b32 v3, 4, v2
  s_mul_i32 s84, s96, 2304
  s_add_u32 s85, s84, 1024
  s_add_u32 s86, s84, 2048
  buffer_store_dwordx4 v[120:123], v3, s[60:63], s84 offen sc1
  buffer_store_dwordx4 v[120:123], v3, s[60:63], s85 offen sc1
  s_mov_b32 exec_lo, 0xffff
  s_mov_b32 exec_hi, 0
  buffer_store_dwordx4 v[120:123], v3, s[60:63], s86 offen sc1
  s_lshl_b32 s84, s96, 10
  s_add_u32 s84, s84, 1048576
  s_mov_b32 exec_lo, -1
  s_mov_b32 exec_hi, 0x1ffff
  buffer_store_dwordx4 v[120:123], v3, s[60:63], s84 offen sc1
  s_add_u32 s84, s84, 262144
  buffer_store_dwordx4 v[120:123], v3, s[60:63], s84 offen sc1
  s_lshl_b32 s84, s29, 5
  s_add_u32 s84, s84, s28
  s_mul_i32 s84, s84, 640
  s_add_u32 s85, s84, 1572864
  s_add_u32 s86, s84, 1835008
  s_mov_b32 exec_hi, 0xff
  buffer_store_dwordx4 v[120:123], v3, s[60:63], s85 offen sc1
  buffer_store_dwordx4 v[120:123], v3, s[60:63], s86 offen sc1
  v_mov_b32 v124, 65536
  s_mov_b64 exec, 1
  s_and_b32 s84, s29, 3
  s_cmp_eq_u32 s84, 0
  s_cbranch_scc0 L_nocnt
  buffer_store_dword v124, off, s[60:63], s97 sc1
L_nocnt:
  s_mov_b64 exec, -1
  s_barrier
  s_mov_b32 s64, s24
  s_mov_b32 s65, s25
  s_mov_b32 s66, 256
  s_mov_b32 s67, 0x20000
  s_getreg_b32 s84, hwreg(HW_REG_XCC_ID)
  s_and_b32 s84, s84, 15
  s_mul_i32 s85, s84, s84
  s_lshl_b32 s85, s85, 16
  s_lshl_b32 s84, s84, 8
  s_add_u32 s84, s84, s85
  s_add_u32 s15, s84, 1
  v_mov_b32 v106, s15
  s_waitcnt vmcnt(0)
  s_mov_b64 exec, 1
  buffer_atomic_add v106, off, s[64:67], s95
  s_mov_b64 exec, -1
  s_branch L_control
L_noclr:
  s_barrier

  s_sub_u32 s84, s30, 11
  s_cmp_lt_u32 s84, 4
  s_cbranch_scc0 L_role_15
  s_mul_i32 s86, s28, 61440
  s_mul_i32 s85, s29, 160
  s_add_u32 s86, s86, s85
  s_add_u32 s52, s20, s86
  s_addc_u32 s53, s21, 0
  s_mov_b32 s54, 60320
  s_mov_b32 s55, 0x20000
  v_lshrrev_b32 v3, 4, v2
  v_mul_u32_u24 v3, 1280, v3
  v_and_b32 v6, 15, v2
  v_lshl_add_u32 v3, v6, 4, v3
  s_mul_i32 s85, s84, 3072
  s_mul_i32 s84, s84, 15360
  s_mov_b32 exec_lo, 0x03ff03ff
  s_mov_b32 exec_hi, 0x03ff03ff
  s_add_u32 m0, s85, 71680
  s_add_u32 s86, s84, 0
  buffer_load_dwordx4 v3, s[52:55], s86 offen nt lds
  s_add_u32 m0, s85, 72704
  s_add_u32 s86, s84, 5120
  buffer_load_dwordx4 v3, s[52:55], s86 offen nt lds
  s_add_u32 m0, s85, 73728
  s_add_u32 s86, s84, 10240
  buffer_load_dwordx4 v3, s[52:55], s86 offen nt lds
  s_mov_b64 exec, -1
  s_branch L_role_done
L_role_15:
L_role_done:
  s_add_u32 s77, s76, 3072
  s_add_u32 s78, s76, 6144
  s_add_u32 s79, s76, 9216
  s_add_u32 s80, s76, 12288
  s_add_u32 s81, s76, 15360
  s_add_u32 s82, s76, 18432
  buffer_load_dwordx4 v[8:11], v1, s[32:35], s76 offen offset:0 nt
  buffer_load_dwordx4 v[12:15], v1, s[32:35], s76 offen offset:128 nt
  buffer_load_dwordx4 v[16:19], v1, s[32:35], s76 offen offset:256 nt
  s_add_u32 s36, s8, s101
  s_addc_u32 s37, s9, 0
  s_mov_b32 s38, 1572864
  s_mov_b32 s39, 0x20000
  s_mov_b32 s60, s26
  s_mov_b32 s61, s27
  s_mov_b32 s62, 2097152
  s_mov_b32 s63, 0x20000
  s_mov_b32 s64, s24
  s_mov_b32 s65, s25
  s_mov_b32 s66, 256
  s_mov_b32 s67, 0x20000
  s_mov_b32 s68, s4
  s_mov_b32 s69, s5
  s_mov_b32 s70, 2560
  s_mov_b32 s71, 0x20000
  s_mov_b32 s72, s22
  s_mov_b32 s73, s23
  s_mov_b32 s74, 2560
  s_mov_b32 s75, 0x20000
  s_mul_i32 s84, s28, 245760
  s_mul_i32 s85, s29, 160
  s_add_u32 s84, s84, s85
  s_add_u32 s56, s12, s84
  s_addc_u32 s57, s13, 0
  s_mov_b32 s58, 244640
  s_mov_b32 s59, 0x20000
  s_mov_b32 s92, 0xff00ff00
  s_mov_b32 s93, 0xff00ff00
  s_cmp_lt_u32 s3, 2
  s_cbranch_scc0 L_noln
  s_waitcnt vmcnt(8)
  v_lshlrev_b32 v105, 16, v100
  v_and_b32 v106, 0xffff0000, v100
  v_lshlrev_b32 v107, 16, v101
  v_and_b32 v108, 0xffff0000, v101
  v_lshlrev_b32 v109, 16, v102
  v_and_b32 v110, 0xffff0000, v102
  v_lshlrev_b32 v111, 16, v103
  v_and_b32 v112, 0xffff0000, v103
  v_lshlrev_b32 v113, 16, v104
  v_and_b32 v114, 0xffff0000, v104
  v_add_f32 v115, v105, v106
  v_add_f32 v115, v115, v107
  v_add_f32 v115, v115, v108
  v_add_f32 v115, v115, v109
  v_add_f32 v115, v115, v110
  v_add_f32 v115, v115, v111
  v_add_f32 v115, v115, v112
  v_add_f32 v115, v115, v113
  v_add_f32 v115, v115, v114
  s_nop 1
  v_add_f32_dpp v115, v115, v115 quad_perm:[1,0,3,2] row_mask:0xf bank_mask:0xf
  s_nop 1
  v_add_f32_dpp v115, v115, v115 quad_perm:[2,3,0,1] row_mask:0xf bank_mask:0xf
  s_nop 1
  v_add_f32_dpp v115, v115, v115 row_half_mirror row_mask:0xf bank_mask:0xf
  s_nop 1
  v_add_f32_dpp v115, v115, v115 row_ror:8 row_mask:0xf bank_mask:0xf
  v_mov_b32 v116, v115
  s_nop 1
  v_permlane16_swap_b32 v115, v116
  v_add_f32 v115, v115, v116
  v_mov_b32 v116, v115
  s_nop 1
  v_permlane32_swap_b32 v115, v116
  v_add_f32 v115, v115, v116
  v_mul_f32 v115, 0x3acccccd, v115
  v_mov_b32 v117, 0
  v_sub_f32 v116, v105, v115
  v_fmac_f32 v117, v116, v116
  v_sub_f32 v116, v106, v115
  v_fmac_f32 v117, v116, v116
  v_sub_f32 v116, v107, v115
  v_fmac_f32 v117, v116, v116
  v_sub_f32 v116, v108, v115
  v_fmac_f32 v117, v116, v116
  v_sub_f32 v116, v109, v115
  v_fmac_f32 v117, v116, v116
  v_sub_f32 v116, v110, v115
  v_fmac_f32 v117, v116, v116
  v_sub_f32 v116, v111, v115
  v_fmac_f32 v117, v116, v116
  v_sub_f32 v116, v112, v115
  v_fmac_f32 v117, v116, v116
  v_sub_f32 v116, v113, v115
  v_fmac_f32 v117, v116, v116
  v_sub_f32 v116, v114, v115
  v_fmac_f32 v117, v116, v116
  s_nop 1
  v_add_f32_dpp v117, v117, v117 quad_perm:[1,0,3,2] row_mask:0xf bank_mask:0xf
  s_nop 1
  v_add_f32_dpp v117, v117, v117 quad_perm:[2,3,0,1] row_mask:0xf bank_mask:0xf
  s_nop 1
  v_add_f32_dpp v117, v117, v117 row_half_mirror row_mask:0xf bank_mask:0xf
  s_nop 1
  v_add_f32_dpp v117, v117, v117 row_ror:8 row_mask:0xf bank_mask:0xf
  v_mov_b32 v116, v117
  s_nop 1
  v_permlane16_swap_b32 v117, v116
  v_add_f32 v117, v117, v116
  v_mov_b32 v116, v117
  s_nop 1
  v_permlane32_swap_b32 v117, v116
  v_add_f32 v117, v117, v116
  v_mul_f32 v117, 0x3acccccd, v117
  v_cvt_pk_bf16_f32 v117, v117, v117
  v_and_b32 v117, 0xffff0000, v117
  v_add_f32 v117, 0x3727c5ac, v117
  v_cvt_pk_bf16_f32 v117, v117, v117
  v_and_b32 v117, 0xffff0000, v117
  v_sqrt_f32 v117, v117
  s_nop 0
  v_cvt_pk_bf16_f32 v117, v117, v117
  v_and_b32 v117, 0xffff0000, v117
  v_rcp_f32 v118, v117
  v_cvt_pk_bf16_f32 v115, v115, v115
  v_and_b32 v115, 0xffff0000, v115
  v_sub_f32 v105, v105, v115
  v_sub_f32 v106, v106, v115
  v_sub_f32 v107, v107, v115
  v_sub_f32 v108, v108, v115
  v_sub_f32 v109, v109, v115
  v_sub_f32 v110, v110, v115
  v_sub_f32 v111, v111, v115
  v_sub_f32 v112, v112, v115
  v_sub_f32 v113, v113, v115
  v_sub_f32 v114, v114, v115
  v_cvt_pk_bf16_f32 v116, v105, v106
  v_lshlrev_b32 v105, 16, v116
  v_and_b32 v106, 0xffff0000, v116
  v_cvt_pk_bf16_f32 v116, v107, v108
  v_lshlrev_b32 v107, 16, v116
  v_and_b32 v108, 0xffff0000, v116
  v_cvt_pk_bf16_f32 v116, v109, v110
  v_lshlrev_b32 v109, 16, v116
  v_and_b32 v110, 0xffff0000, v116
  v_cvt_pk_bf16_f32 v116, v111, v112
  v_lshlrev_b32 v111, 16, v116
  v_and_b32 v112, 0xffff0000, v116
  v_cvt_pk_bf16_f32 v116, v113, v114
  v_lshlrev_b32 v113, 16, v116
  v_and_b32 v114, 0xffff0000, v116
  v_mul_f32 v116, v105, v118
  v_fma_f32 v119, -v116, v117, v105
  v_fma_f32 v105, v119, v118, v116
  v_mul_f32 v116, v106, v118
  v_fma_f32 v119, -v116, v117, v106
  v_fma_f32 v106, v119, v118, v116
  v_mul_f32 v116, v107, v118
  v_fma_f32 v119, -v116, v117, v107
  v_fma_f32 v107, v119, v118, v116
  v_mul_f32 v116, v108, v118
  v_fma_f32 v119, -v116, v117, v108
  v_fma_f32 v108, v119, v118, v116
  v_mul_f32 v116, v109, v118
  v_fma_f32 v119, -v116, v117, v109
  v_fma_f32 v109, v119, v118, v116
  v_mul_f32 v116, v110, v118
  v_fma_f32 v119, -v116, v117, v110
  v_fma_f32 v110, v119, v118, v116
  v_mul_f32 v116, v111, v118
  v_fma_f32 v119, -v116, v117, v111
  v_fma_f32 v111, v119, v118, v116
  v_mul_f32 v116, v112, v118
  v_fma_f32 v119, -v116, v117, v112
  v_fma_f32 v112, v119, v118, v116
  v_mul_f32 v116, v113, v118
  v_fma_f32 v119, -v116, v117, v113
  v_fma_f32 v113, v119, v118, v116
  v_mul_f32 v116, v114, v118
  v_fma_f32 v119, -v116, v117, v114
  v_fma_f32 v114, v119, v118, v116
  v_lshlrev_b32 v3, 2, v2
  s_mul_i32 s84, s3, 1280
  v_add_u32 v3, s84, v3
  v_cvt_pk_bf16_f32 v116, v105, v106
  ds_write_b32 v3, v116 offset:0
  v_cvt_pk_bf16_f32 v116, v107, v108
  ds_write_b32 v3, v116 offset:256
  v_cvt_pk_bf16_f32 v116, v109, v110
  ds_write_b32 v3, v116 offset:512
  v_cvt_pk_bf16_f32 v116, v111, v112
  ds_write_b32 v3, v116 offset:768
  v_cvt_pk_bf16_f32 v116, v113, v114
  ds_write_b32 v3, v116 offset:1024
L_noln:
  s_cmp_lt_u32 s3, 10
  s_cbranch_scc1 L_cnt_w1
  s_sub_u32 s84, s30, 11
  s_cmp_lt_u32 s84, 4
  s_cbranch_scc0 L_stream
  s_waitcnt vmcnt(3)
  v_mov_b32 v100, 3984
  v_mov_b32 v101, 1
  s_mov_b64 exec, 1
  ds_add_u32 v100, v101
  s_mov_b64 exec, -1
  s_branch L_stream
L_cnt_w1:
  s_waitcnt vmcnt(3) lgkmcnt(0)
  v_mov_b32 v100, 3980
  v_mov_b32 v101, 1
  s_mov_b64 exec, 1
  ds_add_u32 v100, v101
  s_mov_b64 exec, -1
  s_cmp_ge_u32 s3, 9
  s_cbranch_scc1 L_stream
  v_mov_b32 v100, 3980
L_spin_w1:
  ds_read_b32 v101, v100
  s_waitcnt lgkmcnt(0)
  v_readfirstlane_b32 s87, v101
  s_cmp_ge_u32 s87, 10
  s_cbranch_scc1 L_spun_w1
  s_sleep 1
  s_branch L_spin_w1
L_spun_w1:
  s_setprio 3
  v_lshrrev_b32 v100, 4, v2
  v_bfe_u32 v101, v2, 2, 2
  v_and_b32 v102, 3, v2
  v_lshlrev_b32 v102, 3, v102
  v_lshl_add_u32 v102, v101, 7, v102
  v_mul_u32_u24 v103, 5120, v100
  v_add_u32 v103, v103, v102
  v_lshrrev_b32 v104, 1, v100
  v_add_u32 v104, 8, v104
  v_mul_u32_u24 v104, 5120, v104
  v_and_b32 v105, 1, v100
  v_lshl_add_u32 v104, v105, 9, v104
  v_add_u32 v104, v104, v102
  v_and_b32 v105, 1, v101
  v_mul_u32_u24 v105, 1280, v105
  s_mul_i32 s84, s29, 160
  v_add_u32 v105, s84, v105
  v_lshl_add_u32 v106, v100, 4, v105
  v_lshl_add_u32 v107, v100, 3, v105
  ds_read_b128 v[32:35], v106 offset:0
  ds_read_b128 v[36:39], v106 offset:64
  ds_read_b64 v[40:41], v107 offset:128
  s_lshl_b32 s87, s3, 1
  s_lshr_b32 s88, s87, 2
  s_lshl_b32 s88, s88, 10
  s_and_b32 s89, s87, 3
  s_lshl_b32 s89, s89, 5
  s_add_u32 s85, s88, s89
  s_cmp_lt_u32 s87, 12
  s_cbranch_scc1 L_toff0
  s_sub_u32 s88, s87, 12
  s_lshl_b32 s88, s88, 5
  s_add_u32 s85, s88, 3072
  s_cmp_lt_u32 s87, 15
  s_cbranch_scc1 L_toff0
  s_sub_u32 s88, s87, 15
  s_lshl_b32 s88, s88, 5
  s_add_u32 s85, s88, 4096
L_toff0:
  v_add_u32 v108, s85, v103
  v_add_u32 v109, s85, v104
  ds_read_b64_tr_b16 v[44:45], v108 offset:20480
  ds_read_b64_tr_b16 v[46:47], v108 offset:20992
  ds_read_b64_tr_b16 v[48:49], v108 offset:40960
  ds_read_b64_tr_b16 v[50:51], v108 offset:41472
  ds_read_b64_tr_b16 v[52:53], v109 offset:20480
  s_lshl_b32 s87, s3, 1
  s_add_u32 s87, s87, 1
  s_lshr_b32 s88, s87, 2
  s_lshl_b32 s88, s88, 10
  s_and_b32 s89, s87, 3
  s_lshl_b32 s89, s89, 5
  s_add_u32 s86, s88, s89
  s_cmp_lt_u32 s87, 12
  s_cbranch_scc1 L_toff1
  s_sub_u32 s88, s87, 12
  s_lshl_b32 s88, s88, 5
  s_add_u32 s86, s88, 3072
  s_cmp_lt_u32 s87, 15
  s_cbranch_scc1 L_toff1
  s_sub_u32 s88, s87, 15
  s_lshl_b32 s88, s88, 5
  s_add_u32 s86, s88, 4096
L_toff1:
  v_add_u32 v108, s86, v103
  v_add_u32 v109, s86, v104
  ds_read_b64_tr_b16 v[56:57], v108 offset:20480
  ds_read_b64_tr_b16 v[58:59], v108 offset:20992
  ds_read_b64_tr_b16 v[60:61], v108 offset:40960
  ds_read_b64_tr_b16 v[62:63], v108 offset:41472
  ds_read_b64_tr_b16 v[64:65], v109 offset:20480
  s_waitcnt lgkmcnt(0)
  v_mfma_f32_16x16x32_bf16 v[68:71], v[32:35], v[44:47], 0
  v_mfma_f32_16x16x32_bf16 v[72:75], v[32:35], v[56:59], 0
  v_mfma_f32_16x16x32_bf16 v[68:71], v[36:39], v[48:51], v[68:71]
  v_mfma_f32_16x16x32_bf16 v[72:75], v[36:39], v[60:63], v[72:75]
  v_mfma_f32_16x16x16_bf16 v[68:71], v[40:41], v[52:53], v[68:71]
  v_mfma_f32_16x16x16_bf16 v[72:75], v[40:41], v[64:65], v[72:75]
  v_and_b32 v105, 15, v2
  v_mul_u32_u24 v106, 1152, v100
  v_lshl_add_u32 v107, v105, 2, v106
  v_lshrrev_b32 v108, 1, v105
  v_lshl_add_u32 v106, v108, 4, v106
  v_and_b32 v108, 1, v105
  v_lshl_add_u32 v106, v108, 2, v106
  s_mul_i32 s84, s96, 2304
  s_lshl_b32 s87, s3, 1
  s_lshl_b32 s85, s87, 6
  s_cmp_lt_u32 s87, 12
  s_cbranch_scc1 L_sb0
  s_sub_u32 s88, s87, 12
  s_lshl_b32 s88, s88, 7
  s_add_u32 s85, s88, 768
  s_cmp_lt_u32 s87, 15
  s_cbranch_scc1 L_sb0
  s_sub_u32 s88, s87, 15
  s_lshl_b32 s88, s88, 7
  s_add_u32 s85, s88, 776
L_sb0:
  s_add_u32 s85, s85, s84
  s_lshl_b32 s87, s3, 1
  s_add_u32 s87, s87, 1
  s_lshl_b32 s86, s87, 6
  s_cmp_lt_u32 s87, 12
  s_cbranch_scc1 L_sb1
  s_sub_u32 s88, s87, 12
  s_lshl_b32 s88, s88, 7
  s_add_u32 s86, s88, 768
  s_cmp_lt_u32 s87, 15
  s_cbranch_scc1 L_sb1
  s_sub_u32 s88, s87, 15
  s_lshl_b32 s88, s88, 7
  s_add_u32 s86, s88, 776
L_sb1:
  s_add_u32 s86, s86, s84
  s_cmp_ge_u32 s3, 6
  s_cbranch_scc0 L_qform
  v_mov_b32 v107, v106
L_qform:
  s_sub_u32 s85, s85, s84
  s_sub_u32 s86, s86, s84
  v_add_u32 v105, s85, v107
  v_add_u32 v106, s86, v107
  s_mov_b32 exec_lo, -1
  s_mov_b32 exec_hi, 0
  s_nop 4
  ds_write_b32 v105, v68 offset:4160
  ds_write_b32 v106, v72 offset:4160
  s_mov_b64 exec, -1
  s_waitcnt lgkmcnt(0)
  v_mov_b32 v105, 3972
  v_mov_b32 v106, 1
  s_mov_b64 exec, 1
  ds_add_u32 v105, v106
  s_mov_b64 exec, -1
  s_setprio 0
L_warm0:
L_stream:
  s_setprio 0
  s_waitcnt vmcnt(1)
  buffer_load_dwordx4 v[20:23], v1, s[32:35], s77 offen offset:0 nt
  s_waitcnt vmcnt(1)
  buffer_load_dwordx4 v[24:27], v1, s[32:35], s77 offen offset:128 nt
  s_waitcnt vmcnt(1)
  buffer_load_dwordx4 v[28:31], v1, s[32:35], s77 offen offset:256 nt
  s_waitcnt vmcnt(1)
  buffer_load_dwordx4 v[32:35], v1, s[32:35], s78 offen offset:0 nt
  s_waitcnt vmcnt(1)
  buffer_load_dwordx4 v[36:39], v1, s[32:35], s78 offen offset:128 nt
  s_waitcnt vmcnt(1)
  buffer_load_dwordx4 v[40:43], v1, s[32:35], s78 offen offset:256 nt
  s_waitcnt vmcnt(1)
  buffer_load_dwordx4 v[44:47], v1, s[32:35], s79 offen offset:0 nt
  s_waitcnt vmcnt(1)
  buffer_load_dwordx4 v[48:51], v1, s[32:35], s79 offen offset:128 nt
  s_waitcnt vmcnt(1)
  buffer_load_dwordx4 v[52:55], v1, s[32:35], s79 offen offset:256 nt
  s_waitcnt vmcnt(1)
  buffer_load_dwordx4 v[56:59], v1, s[32:35], s80 offen offset:0 nt
  s_waitcnt vmcnt(1)
  buffer_load_dwordx4 v[60:63], v1, s[32:35], s80 offen offset:128 nt
  s_waitcnt vmcnt(1)
  buffer_load_dwordx4 v[64:67], v1, s[32:35], s80 offen offset:256 nt
  v_mov_b32 v122, 3968
L_spin_qa:
  ds_read_b32 v123, v122
  s_waitcnt lgkmcnt(0)
  v_readfirstlane_b32 s87, v123
  s_cmp_ge_u32 s87, 1
  s_cbranch_scc1 L_spun_qa
  s_sleep 2
  s_branch L_spin_qa
L_spun_qa:
  v_and_b32 v122, 7, v2
  v_lshlrev_b32 v122, 4, v122
  ds_read_b128 v[68:71], v122 offset:2560
  ds_read_b128 v[72:75], v122 offset:2688
  ds_read_b128 v[76:79], v122 offset:2816
  v_mov_b32 v123, 3996
  ds_read_b32 v124, v123
  s_waitcnt lgkmcnt(0)
  v_readfirstlane_b32 s15, v124
  v_mov_b32 v104, 0
  v_dot2c_f32_bf16 v104, v8, v68
  v_dot2c_f32_bf16 v104, v9, v69
  v_dot2c_f32_bf16 v104, v10, v70
  v_dot2c_f32_bf16 v104, v11, v71
  v_dot2c_f32_bf16 v104, v12, v72
  v_dot2c_f32_bf16 v104, v13, v73
  v_dot2c_f32_bf16 v104, v14, v74
  v_dot2c_f32_bf16 v104, v15, v75
  v_dot2c_f32_bf16 v104, v16, v76
  v_dot2c_f32_bf16 v104, v17, v77
  v_dot2c_f32_bf16 v104, v18, v78
  v_dot2c_f32_bf16 v104, v19, v79
  s_nop 1
  s_nop 1
  v_add_f32_dpp v104, v104, v104 quad_perm:[1,0,3,2] row_mask:0xf bank_mask:0xf
  s_nop 1
  v_add_f32_dpp v104, v104, v104 quad_perm:[2,3,0,1] row_mask:0xf bank_mask:0xf
  s_nop 1
  v_add_f32_dpp v104, v104, v104 row_half_mirror row_mask:0xf bank_mask:0xf
  s_waitcnt vmcnt(1)
  buffer_load_dwordx4 v[8:11], v1, s[32:35], s81 offen offset:0 nt
  v_mov_b32 v106, 0
  v_dot2c_f32_bf16 v106, v20, v68
  v_dot2c_f32_bf16 v106, v21, v69
  v_dot2c_f32_bf16 v106, v22, v70
  v_dot2c_f32_bf16 v106, v23, v71
  v_dot2c_f32_bf16 v106, v24, v72
  v_dot2c_f32_bf16 v106, v25, v73
  v_dot2c_f32_bf16 v106, v26, v74
  v_dot2c_f32_bf16 v106, v27, v75
  v_dot2c_f32_bf16 v106, v28, v76
  v_dot2c_f32_bf16 v106, v29, v77
  v_dot2c_f32_bf16 v106, v30, v78
  v_dot2c_f32_bf16 v106, v31, v79
  s_nop 1
  s_nop 1
  v_add_f32_dpp v106, v106, v106 quad_perm:[1,0,3,2] row_mask:0xf bank_mask:0xf
  s_nop 1
  v_add_f32_dpp v106, v106, v106 quad_perm:[2,3,0,1] row_mask:0xf bank_mask:0xf
  s_nop 1
  v_add_f32_dpp v106, v106, v106 row_half_mirror row_mask:0xf bank_mask:0xf
  s_waitcnt vmcnt(1)
  buffer_load_dwordx4 v[12:15], v1, s[32:35], s81 offen offset:128 nt
  v_mov_b32 v108, 0
  v_dot2c_f32_bf16 v108, v32, v68
  v_dot2c_f32_bf16 v108, v33, v69
  v_dot2c_f32_bf16 v108, v34, v70
  v_dot2c_f32_bf16 v108, v35, v71
  v_dot2c_f32_bf16 v108, v36, v72
  v_dot2c_f32_bf16 v108, v37, v73
  v_dot2c_f32_bf16 v108, v38, v74
  v_dot2c_f32_bf16 v108, v39, v75
  v_dot2c_f32_bf16 v108, v40, v76
  v_dot2c_f32_bf16 v108, v41, v77
  v_dot2c_f32_bf16 v108, v42, v78
  v_dot2c_f32_bf16 v108, v43, v79
  s_nop 1
  s_nop 1
  v_add_f32_dpp v108, v108, v108 quad_perm:[1,0,3,2] row_mask:0xf bank_mask:0xf
  s_nop 1
  v_add_f32_dpp v108, v108, v108 quad_perm:[2,3,0,1] row_mask:0xf bank_mask:0xf
  s_nop 1
  v_add_f32_dpp v108, v108, v108 row_half_mirror row_mask:0xf bank_mask:0xf
  s_waitcnt vmcnt(1)
  buffer_load_dwordx4 v[16:19], v1, s[32:35], s81 offen offset:256 nt
  v_mov_b32 v110, 0
  v_dot2c_f32_bf16 v110, v44, v68
  v_dot2c_f32_bf16 v110, v45, v69
  v_dot2c_f32_bf16 v110, v46, v70
  v_dot2c_f32_bf16 v110, v47, v71
  v_dot2c_f32_bf16 v110, v48, v72
  v_dot2c_f32_bf16 v110, v49, v73
  v_dot2c_f32_bf16 v110, v50, v74
  v_dot2c_f32_bf16 v110, v51, v75
  v_dot2c_f32_bf16 v110, v52, v76
  v_dot2c_f32_bf16 v110, v53, v77
  v_dot2c_f32_bf16 v110, v54, v78
  v_dot2c_f32_bf16 v110, v55, v79
  s_nop 1
  s_nop 1
  v_add_f32_dpp v110, v110, v110 quad_perm:[1,0,3,2] row_mask:0xf bank_mask:0xf
  s_nop 1
  v_add_f32_dpp v110, v110, v110 quad_perm:[2,3,0,1] row_mask:0xf bank_mask:0xf
  s_nop 1
  v_add_f32_dpp v110, v110, v110 row_half_mirror row_mask:0xf bank_mask:0xf
  s_waitcnt vmcnt(1)
  buffer_load_dwordx4 v[20:23], v1, s[32:35], s82 offen offset:0 nt
  v_mov_b32 v112, 0
  v_dot2c_f32_bf16 v112, v56, v68
  v_dot2c_f32_bf16 v112, v57, v69
  v_dot2c_f32_bf16 v112, v58, v70
  v_dot2c_f32_bf16 v112, v59, v71
  v_dot2c_f32_bf16 v112, v60, v72
  v_dot2c_f32_bf16 v112, v61, v73
  v_dot2c_f32_bf16 v112, v62, v74
  v_dot2c_f32_bf16 v112, v63, v75
  v_dot2c_f32_bf16 v112, v64, v76
  v_dot2c_f32_bf16 v112, v65, v77
  v_dot2c_f32_bf16 v112, v66, v78
  v_dot2c_f32_bf16 v112, v67, v79
  s_nop 1
  s_nop 1
  v_add_f32_dpp v112, v112, v112 quad_perm:[1,0,3,2] row_mask:0xf bank_mask:0xf
  s_nop 1
  v_add_f32_dpp v112, v112, v112 quad_perm:[2,3,0,1] row_mask:0xf bank_mask:0xf
  s_nop 1
  v_add_f32_dpp v112, v112, v112 row_half_mirror row_mask:0xf bank_mask:0xf
  s_waitcnt vmcnt(1)
  buffer_load_dwordx4 v[24:27], v1, s[32:35], s82 offen offset:128 nt
  v_mov_b32 v114, 0
  v_dot2c_f32_bf16 v114, v8, v68
  v_dot2c_f32_bf16 v114, v9, v69
  v_dot2c_f32_bf16 v114, v10, v70
  v_dot2c_f32_bf16 v114, v11, v71
  v_dot2c_f32_bf16 v114, v12, v72
  v_dot2c_f32_bf16 v114, v13, v73
  v_dot2c_f32_bf16 v114, v14, v74
  v_dot2c_f32_bf16 v114, v15, v75
  v_dot2c_f32_bf16 v114, v16, v76
  v_dot2c_f32_bf16 v114, v17, v77
  v_dot2c_f32_bf16 v114, v18, v78
  v_dot2c_f32_bf16 v114, v19, v79
  s_nop 1
  s_nop 1
  v_add_f32_dpp v114, v114, v114 quad_perm:[1,0,3,2] row_mask:0xf bank_mask:0xf
  s_nop 1
  v_add_f32_dpp v114, v114, v114 quad_perm:[2,3,0,1] row_mask:0xf bank_mask:0xf
  s_nop 1
  v_add_f32_dpp v114, v114, v114 row_half_mirror row_mask:0xf bank_mask:0xf
  s_waitcnt vmcnt(1)
  buffer_load_dwordx4 v[28:31], v1, s[32:35], s82 offen offset:256 nt
  s_waitcnt vmcnt(1)
  buffer_load_dwordx4 v[32:35], v1, s[36:39], s76 offen offset:0 nt
  s_waitcnt vmcnt(1)
  buffer_load_dwordx4 v[36:39], v1, s[36:39], s76 offen offset:128 nt
  v_mov_b32 v116, 0
  v_dot2c_f32_bf16 v116, v20, v68
  v_dot2c_f32_bf16 v116, v21, v69
  v_dot2c_f32_bf16 v116, v22, v70
  v_dot2c_f32_bf16 v116, v23, v71
  v_dot2c_f32_bf16 v116, v24, v72
  v_dot2c_f32_bf16 v116, v25, v73
  v_dot2c_f32_bf16 v116, v26, v74
  v_dot2c_f32_bf16 v116, v27, v75
  v_dot2c_f32_bf16 v116, v28, v76
  v_dot2c_f32_bf16 v116, v29, v77
  v_dot2c_f32_bf16 v116, v30, v78
  v_dot2c_f32_bf16 v116, v31, v79
  s_nop 1
  s_nop 1
  v_add_f32_dpp v116, v116, v116 quad_perm:[1,0,3,2] row_mask:0xf bank_mask:0xf
  s_nop 1
  v_add_f32_dpp v116, v116, v116 quad_perm:[2,3,0,1] row_mask:0xf bank_mask:0xf
  s_nop 1
  v_add_f32_dpp v116, v116, v116 row_half_mirror row_mask:0xf bank_mask:0xf
  v_cvt_pk_bf16_f32 v104, v104, v104
  v_cvt_pk_bf16_f32 v106, v106, v106
  v_cvt_pk_bf16_f32 v108, v108, v108
  v_cvt_pk_bf16_f32 v110, v110, v110
  v_cvt_pk_bf16_f32 v112, v112, v112
  v_cvt_pk_bf16_f32 v114, v114, v114
  v_cvt_pk_bf16_f32 v116, v116, v116
  v_and_b32 v104, 0xffff0000, v104
  v_and_b32 v106, 0xffff0000, v106
  v_and_b32 v108, 0xffff0000, v108
  v_and_b32 v110, 0xffff0000, v110
  v_and_b32 v112, 0xffff0000, v112
  v_and_b32 v114, 0xffff0000, v114
  v_and_b32 v116, 0xffff0000, v116
  v_mul_f32 v104, 0x3d93cd3a, v104
  v_mul_f32 v106, 0x3d93cd3a, v106
  v_mul_f32 v108, 0x3d93cd3a, v108
  v_mul_f32 v110, 0x3d93cd3a, v110
  v_mul_f32 v112, 0x3d93cd3a, v112
  v_mul_f32 v114, 0x3d93cd3a, v114
  v_mul_f32 v116, 0x3d93cd3a, v116
  v_cvt_pk_bf16_f32 v104, v104, v104
  v_cvt_pk_bf16_f32 v106, v106, v106
  v_cvt_pk_bf16_f32 v108, v108, v108
  v_cvt_pk_bf16_f32 v110, v110, v110
  v_cvt_pk_bf16_f32 v112, v112, v112
  v_cvt_pk_bf16_f32 v114, v114, v114
  v_cvt_pk_bf16_f32 v116, v116, v116
  v_and_b32 v104, 0xffff0000, v104
  v_and_b32 v106, 0xffff0000, v106
  v_and_b32 v108, 0xffff0000, v108
  v_and_b32 v110, 0xffff0000, v110
  v_and_b32 v112, 0xffff0000, v112
  v_and_b32 v114, 0xffff0000, v114
  v_and_b32 v116, 0xffff0000, v116
  v_mov_b32 v118, v104
  v_max_f32 v118, v118, v106
  v_max_f32 v118, v118, v108
  v_max_f32 v118, v118, v110
  v_max_f32 v118, v118, v112
  v_max_f32 v118, v118, v114
  v_max_f32 v118, v118, v116
  v_mul_f32 v118, 0x3fb8aa3b, v118
  s_mov_b32 s84, 0x3fb8aa3b
  v_fma_f32 v104, v104, s84, -v118
  v_fma_f32 v106, v106, s84, -v118
  v_fma_f32 v108, v108, s84, -v118
  v_fma_f32 v110, v110, s84, -v118
  v_fma_f32 v112, v112, s84, -v118
  v_fma_f32 v114, v114, s84, -v118
  v_fma_f32 v116, v116, s84, -v118
  v_exp_f32 v104, v104
  v_exp_f32 v106, v106
  v_exp_f32 v108, v108
  v_exp_f32 v110, v110
  v_exp_f32 v112, v112
  v_exp_f32 v114, v114
  v_exp_f32 v116, v116
  s_nop 0
  v_mov_b32 v119, v104
  v_add_f32 v119, v119, v106
  v_add_f32 v119, v119, v108
  v_add_f32 v119, v119, v110
  v_add_f32 v119, v119, v112
  v_add_f32 v119, v119, v114
  v_add_f32 v119, v119, v116
  v_cvt_pk_bf16_f32 v104, v104, v104
  v_cvt_pk_bf16_f32 v106, v106, v106
  v_cvt_pk_bf16_f32 v108, v108, v108
  v_cvt_pk_bf16_f32 v110, v110, v110
  v_cvt_pk_bf16_f32 v112, v112, v112
  v_cvt_pk_bf16_f32 v114, v114, v114
  v_cvt_pk_bf16_f32 v116, v116, v116
  v_and_b32 v105, 0xffff0000, v104
  v_lshrrev_b32 v104, 16, v104
  v_and_b32 v107, 0xffff0000, v106
  v_lshrrev_b32 v106, 16, v106
  v_and_b32 v109, 0xffff0000, v108
  v_lshrrev_b32 v108, 16, v108
  v_and_b32 v111, 0xffff0000, v110
  v_lshrrev_b32 v110, 16, v110
  v_and_b32 v113, 0xffff0000, v112
  v_lshrrev_b32 v112, 16, v112
  v_and_b32 v115, 0xffff0000, v114
  v_lshrrev_b32 v114, 16, v114
  v_and_b32 v117, 0xffff0000, v116
  v_lshrrev_b32 v116, 16, v116
  v_mov_b32 v80, 0
  v_mov_b32 v81, 0
  v_mov_b32 v82, 0
  v_mov_b32 v83, 0
  v_mov_b32 v84, 0
  v_mov_b32 v85, 0
  v_mov_b32 v86, 0
  v_mov_b32 v87, 0
  v_mov_b32 v88, 0
  v_mov_b32 v89, 0
  v_mov_b32 v90, 0
  v_mov_b32 v91, 0
  v_mov_b32 v92, 0
  v_mov_b32 v93, 0
  v_mov_b32 v94, 0
  v_mov_b32 v95, 0
  v_mov_b32 v96, 0
  v_mov_b32 v97, 0
  v_mov_b32 v98, 0
  v_mov_b32 v99, 0
  v_mov_b32 v100, 0
  v_mov_b32 v101, 0
  v_mov_b32 v102, 0
  v_mov_b32 v103, 0
  s_waitcnt vmcnt(1)
  buffer_load_dwordx4 v[40:43], v1, s[36:39], s76 offen offset:256 nt
  v_dot2c_f32_bf16 v80, v32, v104
  v_dot2c_f32_bf16 v81, v32, v105
  v_dot2c_f32_bf16 v82, v33, v104
  v_dot2c_f32_bf16 v83, v33, v105
  v_dot2c_f32_bf16 v84, v34, v104
  v_dot2c_f32_bf16 v85, v34, v105
  v_dot2c_f32_bf16 v86, v35, v104
  v_dot2c_f32_bf16 v87, v35, v105
  s_waitcnt vmcnt(1)
  buffer_load_dwordx4 v[44:47], v1, s[36:39], s77 offen offset:0 nt
  v_dot2c_f32_bf16 v88, v36, v104
  v_dot2c_f32_bf16 v89, v36, v105
  v_dot2c_f32_bf16 v90, v37, v104
  v_dot2c_f32_bf16 v91, v37, v105
  v_dot2c_f32_bf16 v92, v38, v104
  v_dot2c_f32_bf16 v93, v38, v105
  v_dot2c_f32_bf16 v94, v39, v104
  v_dot2c_f32_bf16 v95, v39, v105
  s_waitcnt vmcnt(1)
  buffer_load_dwordx4 v[48:51], v1, s[36:39], s77 offen offset:128 nt
  v_dot2c_f32_bf16 v96, v40, v104
  v_dot2c_f32_bf16 v97, v40, v105
  v_dot2c_f32_bf16 v98, v41, v104
  v_dot2c_f32_bf16 v99, v41, v105
  v_dot2c_f32_bf16 v100, v42, v104
  v_dot2c_f32_bf16 v101, v42, v105
  v_dot2c_f32_bf16 v102, v43, v104
  v_dot2c_f32_bf16 v103, v43, v105
  s_waitcnt vmcnt(1)
  buffer_load_dwordx4 v[52:55], v1, s[36:39], s77 offen offset:256 nt
  v_dot2c_f32_bf16 v80, v44, v106
  v_dot2c_f32_bf16 v81, v44, v107
  v_dot2c_f32_bf16 v82, v45, v106
  v_dot2c_f32_bf16 v83, v45, v107
  v_dot2c_f32_bf16 v84, v46, v106
  v_dot2c_f32_bf16 v85, v46, v107
  v_dot2c_f32_bf16 v86, v47, v106
  v_dot2c_f32_bf16 v87, v47, v107
  s_waitcnt vmcnt(1)
  buffer_load_dwordx4 v[56:59], v1, s[36:39], s78 offen offset:0 nt
  v_dot2c_f32_bf16 v88, v48, v106
  v_dot2c_f32_bf16 v89, v48, v107
  v_dot2c_f32_bf16 v90, v49, v106
  v_dot2c_f32_bf16 v91, v49, v107
  v_dot2c_f32_bf16 v92, v50, v106
  v_dot2c_f32_bf16 v93, v50, v107
  v_dot2c_f32_bf16 v94, v51, v106
  v_dot2c_f32_bf16 v95, v51, v107
  s_waitcnt vmcnt(1)
  buffer_load_dwordx4 v[60:63], v1, s[36:39], s78 offen offset:128 nt
  v_dot2c_f32_bf16 v96, v52, v106
  v_dot2c_f32_bf16 v97, v52, v107
  v_dot2c_f32_bf16 v98, v53, v106
  v_dot2c_f32_bf16 v99, v53, v107
  v_dot2c_f32_bf16 v100, v54, v106
  v_dot2c_f32_bf16 v101, v54, v107
  v_dot2c_f32_bf16 v102, v55, v106
  v_dot2c_f32_bf16 v103, v55, v107
  s_waitcnt vmcnt(1)
  buffer_load_dwordx4 v[64:67], v1, s[36:39], s78 offen offset:256 nt
  v_dot2c_f32_bf16 v80, v56, v108
  v_dot2c_f32_bf16 v81, v56, v109
  v_dot2c_f32_bf16 v82, v57, v108
  v_dot2c_f32_bf16 v83, v57, v109
  v_dot2c_f32_bf16 v84, v58, v108
  v_dot2c_f32_bf16 v85, v58, v109
  v_dot2c_f32_bf16 v86, v59, v108
  v_dot2c_f32_bf16 v87, v59, v109
  s_waitcnt vmcnt(1)
  buffer_load_dwordx4 v[8:11], v1, s[36:39], s79 offen offset:0 nt
  v_dot2c_f32_bf16 v88, v60, v108
  v_dot2c_f32_bf16 v89, v60, v109
  v_dot2c_f32_bf16 v90, v61, v108
  v_dot2c_f32_bf16 v91, v61, v109
  v_dot2c_f32_bf16 v92, v62, v108
  v_dot2c_f32_bf16 v93, v62, v109
  v_dot2c_f32_bf16 v94, v63, v108
  v_dot2c_f32_bf16 v95, v63, v109
  s_waitcnt vmcnt(1)
  buffer_load_dwordx4 v[12:15], v1, s[36:39], s79 offen offset:128 nt
  v_dot2c_f32_bf16 v96, v64, v108
  v_dot2c_f32_bf16 v97, v64, v109
  v_dot2c_f32_bf16 v98, v65, v108
  v_dot2c_f32_bf16 v99, v65, v109
  v_dot2c_f32_bf16 v100, v66, v108
  v_dot2c_f32_bf16 v101, v66, v109
  v_dot2c_f32_bf16 v102, v67, v108
  v_dot2c_f32_bf16 v103, v67, v109
  s_waitcnt vmcnt(1)
  buffer_load_dwordx4 v[16:19], v1, s[36:39], s79 offen offset:256 nt
  v_dot2c_f32_bf16 v80, v8, v110
  v_dot2c_f32_bf16 v81, v8, v111
  v_dot2c_f32_bf16 v82, v9, v110
  v_dot2c_f32_bf16 v83, v9, v111
  v_dot2c_f32_bf16 v84, v10, v110
  v_dot2c_f32_bf16 v85, v10, v111
  v_dot2c_f32_bf16 v86, v11, v110
  v_dot2c_f32_bf16 v87, v11, v111
  s_waitcnt vmcnt(1)
  buffer_load_dwordx4 v[20:23], v1, s[36:39], s80 offen offset:0 nt
  v_dot2c_f32_bf16 v88, v12, v110
  v_dot2c_f32_bf16 v89, v12, v111
  v_dot2c_f32_bf16 v90, v13, v110
  v_dot2c_f32_bf16 v91, v13, v111
  v_dot2c_f32_bf16 v92, v14, v110
  v_dot2c_f32_bf16 v93, v14, v111
  v_dot2c_f32_bf16 v94, v15, v110
  v_dot2c_f32_bf16 v95, v15, v111
  s_waitcnt vmcnt(1)
  buffer_load_dwordx4 v[24:27], v1, s[36:39], s80 offen offset:128 nt
  v_dot2c_f32_bf16 v96, v16, v110
  v_dot2c_f32_bf16 v97, v16, v111
  v_dot2c_f32_bf16 v98, v17, v110
  v_dot2c_f32_bf16 v99, v17, v111
  v_dot2c_f32_bf16 v100, v18, v110
  v_dot2c_f32_bf16 v101, v18, v111
  v_dot2c_f32_bf16 v102, v19, v110
  v_dot2c_f32_bf16 v103, v19, v111
  s_waitcnt vmcnt(1)
  buffer_load_dwordx4 v[28:31], v1, s[36:39], s80 offen offset:256 nt
  v_dot2c_f32_bf16 v80, v20, v112
  v_dot2c_f32_bf16 v81, v20, v113
  v_dot2c_f32_bf16 v82, v21, v112
  v_dot2c_f32_bf16 v83, v21, v113
  v_dot2c_f32_bf16 v84, v22, v112
  v_dot2c_f32_bf16 v85, v22, v113
  v_dot2c_f32_bf16 v86, v23, v112
  v_dot2c_f32_bf16 v87, v23, v113
  s_waitcnt vmcnt(1)
  buffer_load_dwordx4 v[32:35], v1, s[36:39], s81 offen offset:0 nt
  v_mov_b32 v121, 3992
  v_mov_b32 v126, 1
  s_mov_b64 exec, 1
  ds_add_rtn_u32 v121, v121, v126
  s_mov_b64 exec, -1
  s_waitcnt lgkmcnt(0)
  v_dot2c_f32_bf16 v88, v24, v112
  v_dot2c_f32_bf16 v89, v24, v113
  v_dot2c_f32_bf16 v90, v25, v112
  v_dot2c_f32_bf16 v91, v25, v113
  v_dot2c_f32_bf16 v92, v26, v112
  v_dot2c_f32_bf16 v93, v26, v113
  v_dot2c_f32_bf16 v94, v27, v112
  v_dot2c_f32_bf16 v95, v27, v113
  s_waitcnt vmcnt(1)
  buffer_load_dwordx4 v[36:39], v1, s[36:39], s81 offen offset:128 nt
  v_dot2c_f32_bf16 v96, v28, v112
  v_dot2c_f32_bf16 v97, v28, v113
  v_dot2c_f32_bf16 v98, v29, v112
  v_dot2c_f32_bf16 v99, v29, v113
  v_dot2c_f32_bf16 v100, v30, v112
  v_dot2c_f32_bf16 v101, v30, v113
  v_dot2c_f32_bf16 v102, v31, v112
  v_dot2c_f32_bf16 v103, v31, v113
  s_waitcnt vmcnt(1)
  buffer_load_dwordx4 v[40:43], v1, s[36:39], s81 offen offset:256 nt
  v_dot2c_f32_bf16 v80, v32, v114
  v_dot2c_f32_bf16 v81, v32, v115
  v_dot2c_f32_bf16 v82, v33, v114
  v_dot2c_f32_bf16 v83, v33, v115
  v_dot2c_f32_bf16 v84, v34, v114
  v_dot2c_f32_bf16 v85, v34, v115
  v_dot2c_f32_bf16 v86, v35, v114
  v_dot2c_f32_bf16 v87, v35, v115
  s_waitcnt vmcnt(1)
  buffer_load_dwordx4 v[44:47], v1, s[36:39], s82 offen offset:0 nt
  v_dot2c_f32_bf16 v88, v36, v114
  v_dot2c_f32_bf16 v89, v36, v115
  v_dot2c_f32_bf16 v90, v37, v114
  v_dot2c_f32_bf16 v91, v37, v115
  v_dot2c_f32_bf16 v92, v38, v114
  v_dot2c_f32_bf16 v93, v38, v115
  v_dot2c_f32_bf16 v94, v39, v114
  v_dot2c_f32_bf16 v95, v39, v115
  s_waitcnt vmcnt(1)
  buffer_load_dwordx4 v[48:51], v1, s[36:39], s82 offen offset:128 nt
  v_dot2c_f32_bf16 v96, v40, v114
  v_dot2c_f32_bf16 v97, v40, v115
  v_dot2c_f32_bf16 v98, v41, v114
  v_dot2c_f32_bf16 v99, v41, v115
  v_dot2c_f32_bf16 v100, v42, v114
  v_dot2c_f32_bf16 v101, v42, v115
  v_dot2c_f32_bf16 v102, v43, v114
  v_dot2c_f32_bf16 v103, v43, v115
  s_waitcnt vmcnt(1)
  buffer_load_dwordx4 v[52:55], v1, s[36:39], s82 offen offset:256 nt
  v_dot2c_f32_bf16 v80, v44, v116
  v_dot2c_f32_bf16 v81, v44, v117
  v_dot2c_f32_bf16 v82, v45, v116
  v_dot2c_f32_bf16 v83, v45, v117
  v_dot2c_f32_bf16 v84, v46, v116
  v_dot2c_f32_bf16 v85, v46, v117
  v_dot2c_f32_bf16 v86, v47, v116
  v_dot2c_f32_bf16 v87, v47, v117
  s_mov_b32 s94, 262144
L_cl0_a:
  v_readfirstlane_b32 s100, v121
  s_cmp_ge_u32 s100, 0
  s_cbranch_scc1 L_cl0ok_a
  s_sleep 1
  s_sub_u32 s94, s94, 1
  s_cmp_lg_u32 s94, 0
  s_cbranch_scc1 L_cl0_a
L_cl0ok_a:
  s_sub_u32 s100, s100, 0
  s_cmp_ge_u32 s100, s90
  s_cbranch_scc1 L_nodyn_a
  s_mul_i32 s101, s100, 3072
  s_add_u32 s101, s101, s91
  buffer_load_dwordx4 v[56:59], v1, s[32:35], s101 offen offset:0 nt
  buffer_load_dwordx4 v[60:63], v1, s[32:35], s101 offen offset:128 nt
  buffer_load_dwordx4 v[64:67], v1, s[32:35], s101 offen offset:256 nt
  buffer_load_dwordx4 v[8:11], v1, s[36:39], s101 offen offset:0 nt
  buffer_load_dwordx4 v[12:15], v1, s[36:39], s101 offen offset:128 nt
  buffer_load_dwordx4 v[16:19], v1, s[36:39], s101 offen offset:256 nt
  s_waitcnt vmcnt(7)
  v_dot2c_f32_bf16 v88, v48, v116
  v_dot2c_f32_bf16 v89, v48, v117
  v_dot2c_f32_bf16 v90, v49, v116
  v_dot2c_f32_bf16 v91, v49, v117
  v_dot2c_f32_bf16 v92, v50, v116
  v_dot2c_f32_bf16 v93, v50, v117
  v_dot2c_f32_bf16 v94, v51, v116
  v_dot2c_f32_bf16 v95, v51, v117
  s_waitcnt vmcnt(6)
  v_dot2c_f32_bf16 v96, v52, v116
  v_dot2c_f32_bf16 v97, v52, v117
  v_dot2c_f32_bf16 v98, v53, v116
  v_dot2c_f32_bf16 v99, v53, v117
  v_dot2c_f32_bf16 v100, v54, v116
  v_dot2c_f32_bf16 v101, v54, v117
  v_dot2c_f32_bf16 v102, v55, v116
  v_dot2c_f32_bf16 v103, v55, v117
  s_setprio 0
  s_branch L_dyn_mid
L_nodyn_a:
  s_waitcnt vmcnt(1)
  v_dot2c_f32_bf16 v88, v48, v116
  v_dot2c_f32_bf16 v89, v48, v117
  v_dot2c_f32_bf16 v90, v49, v116
  v_dot2c_f32_bf16 v91, v49, v117
  v_dot2c_f32_bf16 v92, v50, v116
  v_dot2c_f32_bf16 v93, v50, v117
  v_dot2c_f32_bf16 v94, v51, v116
  v_dot2c_f32_bf16 v95, v51, v117
  s_waitcnt vmcnt(0)
  v_dot2c_f32_bf16 v96, v52, v116
  v_dot2c_f32_bf16 v97, v52, v117
  v_dot2c_f32_bf16 v98, v53, v116
  v_dot2c_f32_bf16 v99, v53, v117
  v_dot2c_f32_bf16 v100, v54, v116
  v_dot2c_f32_bf16 v101, v54, v117
  v_dot2c_f32_bf16 v102, v55, v116
  v_dot2c_f32_bf16 v103, v55, v117
  s_branch L_tail
L_control:
  s_add_u32 s36, s8, s101
  s_addc_u32 s37, s9, 0
  s_mov_b32 s38, 1572864
  s_mov_b32 s39, 0x20000
  s_mov_b32 s60, s26
  s_mov_b32 s61, s27
  s_mov_b32 s62, 2097152
  s_mov_b32 s63, 0x20000
  s_mov_b32 s64, s24
  s_mov_b32 s65, s25
  s_mov_b32 s66, 256
  s_mov_b32 s67, 0x20000
  s_mov_b32 s68, s4
  s_mov_b32 s69, s5
  s_mov_b32 s70, 2560
  s_mov_b32 s71, 0x20000
  s_mov_b32 s72, s22
  s_mov_b32 s73, s23
  s_mov_b32 s74, 2560
  s_mov_b32 s75, 0x20000
  s_mul_i32 s84, s28, 245760
  s_mul_i32 s85, s29, 160
  s_add_u32 s84, s84, s85
  s_add_u32 s56, s12, s84
  s_addc_u32 s57, s13, 0
  s_mov_b32 s58, 244640
  s_mov_b32 s59, 0x20000
  s_mov_b32 s92, 0xff00ff00
  s_mov_b32 s93, 0xff00ff00
  v_mov_b32 v105, 3972
L_spin_tile:
  ds_read_b32 v108, v105
  s_waitcnt lgkmcnt(0)
  v_readfirstlane_b32 s87, v108
  s_cmp_ge_u32 s87, 9
  s_cbranch_scc1 L_spun_tile
  s_sleep 1
  s_branch L_spin_tile
L_spun_tile:
  v_lshlrev_b32 v100, 4, v2
  ds_read_b128 v[32:35], v100 offset:4160
  ds_read_b128 v[36:39], v100 offset:5184
  ds_read_b128 v[40:43], v100 offset:6208
  s_mul_i32 s84, s96, 2304
  s_add_u32 s85, s84, 1024
  s_add_u32 s86, s84, 2048
  s_waitcnt lgkmcnt(0)
  buffer_store_dwordx4 v[32:35], v100, s[60:63], s84 offen sc1
  buffer_store_dwordx4 v[36:39], v100, s[60:63], s85 offen sc1
  s_mov_b32 exec_lo, 0xffff
  s_mov_b32 exec_hi, 0
  buffer_store_dwordx4 v[40:43], v100, s[60:63], s86 offen sc1
  s_mov_b64 exec, -1
  s_mov_b32 s94, 1048576
L_poll1:
  buffer_load_dword v32, off, s[64:67], s95 sc1
  s_waitcnt vmcnt(0)
  v_readfirstlane_b32 s84, v32
  s_nop 0
  s_and_b32 s85, s84, 0xff
  s_cmp_ge_u32 s85, 8
  s_cbranch_scc1 L_poll1_ok
  s_sleep 4
  s_sub_u32 s94, s94, 1
  s_cmp_lg_u32 s94, 0
  s_cbranch_scc1 L_poll1
L_poll1_ok:
  s_lshl_b32 s85, s15, 3
  s_cmp_eq_u32 s84, s85
  s_cselect_b32 s85, 1, 0
  v_mov_b32 v33, s85
  v_mov_b32 v34, 3996
  ds_write_b32 v34, v33
  s_mov_b32 exec_lo, -1
  s_mov_b32 exec_hi, 0xffff
  v_lshlrev_b32 v100, 4, v2
  v_cmp_le_u32 vcc, 24, v2
  v_mov_b32 v101, 768
  v_mov_b32 v102, 1536
  v_cndmask_b32 v101, v101, v102, vcc
  v_add_u32 v101, v101, v100
  s_lshl_b32 s84, s28, 3
  s_mul_i32 s84, s84, 2304
  s_mul_i32 s85, s31, 1152
  s_add_u32 s85, s85, s84
  s_lshl_b32 s84, s28, 3
  s_mul_i32 s84, s84, 2304
  s_mov_b32 s94, 1048576
L_pollg:
  s_mov_b32 s86, s85
  s_mov_b32 s87, s84
  buffer_load_dwordx4 v[32:35], v100, s[60:63], s86 offen sc1
  s_add_u32 s86, s86, 2304
  buffer_load_dwordx4 v[36:39], v100, s[60:63], s86 offen sc1
  s_add_u32 s86, s86, 2304
  buffer_load_dwordx4 v[40:43], v100, s[60:63], s86 offen sc1
  s_add_u32 s86, s86, 2304
  buffer_load_dwordx4 v[44:47], v100, s[60:63], s86 offen sc1
  s_add_u32 s86, s86, 2304
  buffer_load_dwordx4 v[48:51], v100, s[60:63], s86 offen sc1
  s_add_u32 s86, s86, 2304
  buffer_load_dwordx4 v[52:55], v100, s[60:63], s86 offen sc1
  s_add_u32 s86, s86, 2304
  buffer_load_dwordx4 v[56:59], v100, s[60:63], s86 offen sc1
  s_add_u32 s86, s86, 2304
  buffer_load_dwordx4 v[60:63], v100, s[60:63], s86 offen sc1
  buffer_load_dwordx4 v[64:67], v101, s[60:63], s87 offen sc1
  s_add_u32 s87, s87, 2304
  buffer_load_dwordx4 v[68:71], v101, s[60:63], s87 offen sc1
  s_add_u32 s87, s87, 2304
  buffer_load_dwordx4 v[72:75], v101, s[60:63], s87 offen sc1
  s_add_u32 s87, s87, 2304
  buffer_load_dwordx4 v[76:79], v101, s[60:63], s87 offen sc1
  s_add_u32 s87, s87, 2304
  buffer_load_dwordx4 v[80:83], v101, s[60:63], s87 offen sc1
  s_add_u32 s87, s87, 2304
  buffer_load_dwordx4 v[84:87], v101, s[60:63], s87 offen sc1
  s_add_u32 s87, s87, 2304
  buffer_load_dwordx4 v[88:91], v101, s[60:63], s87 offen sc1
  s_add_u32 s87, s87, 2304
  buffer_load_dwordx4 v[92:95], v101, s[60:63], s87 offen sc1
  s_waitcnt vmcnt(0)
  v_max3_u32 v102, v32, v33, v34
  v_max3_u32 v102, v102, v35, v36
  v_max3_u32 v102, v102, v37, v38
  v_max3_u32 v102, v102, v39, v40
  v_max3_u32 v102, v102, v41, v42
  v_max3_u32 v102, v102, v43, v44
  v_max3_u32 v102, v102, v45, v46
  v_max3_u32 v102, v102, v47, v48
  v_max3_u32 v102, v102, v49, v50
  v_max3_u32 v102, v102, v51, v52
  v_max3_u32 v102, v102, v53, v54
  v_max3_u32 v102, v102, v55, v56
  v_max3_u32 v102, v102, v57, v58
  v_max3_u32 v102, v102, v59, v60
  v_max3_u32 v102, v102, v61, v62
  v_max3_u32 v102, v102, v63, v64
  v_max3_u32 v102, v102, v65, v66
  v_max3_u32 v102, v102, v67, v68
  v_max3_u32 v102, v102, v69, v70
  v_max3_u32 v102, v102, v71, v72
  v_max3_u32 v102, v102, v73, v74
  v_max3_u32 v102, v102, v75, v76
  v_max3_u32 v102, v102, v77, v78
  v_max3_u32 v102, v102, v79, v80
  v_max3_u32 v102, v102, v81, v82
  v_max3_u32 v102, v102, v83, v84
  v_max3_u32 v102, v102, v85, v86
  v_max3_u32 v102, v102, v87, v88
  v_max3_u32 v102, v102, v89, v90
  v_max3_u32 v102, v102, v91, v92
  v_max3_u32 v102, v102, v93, v94
  v_max_u32 v102, v102, v95
  v_cmp_eq_u32 vcc, -1, v102
  s_cbranch_vccz L_pollg_ok
  s_sub_u32 s94, s94, 1
  s_cmp_lg_u32 s94, 0
  s_cbranch_scc1 L_pollg
L_pollg_ok:
  v_add_f32 v32, v32, v36
  v_add_f32 v33, v33, v37
  v_add_f32 v34, v34, v38
  v_add_f32 v35, v35, v39
  v_add_f32 v32, v32, v40
  v_add_f32 v33, v33, v41
  v_add_f32 v34, v34, v42
  v_add_f32 v35, v35, v43
  v_add_f32 v32, v32, v44
  v_add_f32 v33, v33, v45
  v_add_f32 v34, v34, v46
  v_add_f32 v35, v35, v47
  v_add_f32 v32, v32, v48
  v_add_f32 v33, v33, v49
  v_add_f32 v34, v34, v50
  v_add_f32 v35, v35, v51
  v_add_f32 v32, v32, v52
  v_add_f32 v33, v33, v53
  v_add_f32 v34, v34, v54
  v_add_f32 v35, v35, v55
  v_add_f32 v32, v32, v56
  v_add_f32 v33, v33, v57
  v_add_f32 v34, v34, v58
  v_add_f32 v35, v35, v59
  v_add_f32 v32, v32, v60
  v_add_f32 v33, v33, v61
  v_add_f32 v34, v34, v62
  v_add_f32 v35, v35, v63
  v_cvt_pk_bf16_f32 v36, v32, v33
  v_cvt_pk_bf16_f32 v37, v34, v35
  v_lshlrev_b32 v102, 3, v2
  ds_write_b64 v102, v[36:37] offset:2560
  v_mov_b32 v103, 3968
  v_mov_b32 v104, 1
  ds_write_b32 v103, v104
  v_add_f32 v64, v64, v68
  v_add_f32 v65, v65, v69
  v_add_f32 v66, v66, v70
  v_add_f32 v67, v67, v71
  v_add_f32 v64, v64, v72
  v_add_f32 v65, v65, v73
  v_add_f32 v66, v66, v74
  v_add_f32 v67, v67, v75
  v_add_f32 v64, v64, v76
  v_add_f32 v65, v65, v77
  v_add_f32 v66, v66, v78
  v_add_f32 v67, v67, v79
  v_add_f32 v64, v64, v80
  v_add_f32 v65, v65, v81
  v_add_f32 v66, v66, v82
  v_add_f32 v67, v67, v83
  v_add_f32 v64, v64, v84
  v_add_f32 v65, v65, v85
  v_add_f32 v66, v66, v86
  v_add_f32 v67, v67, v87
  v_add_f32 v64, v64, v88
  v_add_f32 v65, v65, v89
  v_add_f32 v66, v66, v90
  v_add_f32 v67, v67, v91
  v_add_f32 v64, v64, v92
  v_add_f32 v65, v65, v93
  v_add_f32 v66, v66, v94
  v_add_f32 v67, v67, v95
  v_cvt_pk_bf16_f32 v68, v64, v65
  v_cvt_pk_bf16_f32 v69, v66, v67
  v_lshlrev_b32 v64, 16, v68
  v_and_b32 v65, 0xffff0000, v68
  v_lshlrev_b32 v66, 16, v69
  v_and_b32 v67, 0xffff0000, v69
  s_mov_b32 s84, 0xbdd2d3e8
  v_mov_b32 v72, 0xc0135761
  v_mul_f32 v70, v64, v64
  v_fma_f32 v70, v70, s84, v72
  v_mul_f32 v70, v70, v64
  v_exp_f32 v70, v70
  s_nop 0
  v_add_f32 v70, 1.0, v70
  v_rcp_f32 v71, v70
  s_nop 0
  v_mul_f32 v64, v64, v71
  v_mul_f32 v70, v65, v65
  v_fma_f32 v70, v70, s84, v72
  v_mul_f32 v70, v70, v65
  v_exp_f32 v70, v70
  s_nop 0
  v_add_f32 v70, 1.0, v70
  v_rcp_f32 v71, v70
  s_nop 0
  v_mul_f32 v65, v65, v71
  v_cvt_pk_bf16_f32 v68, v64, v65
  v_lshlrev_b32 v64, 16, v68
  v_and_b32 v65, 0xffff0000, v68
  v_mul_f32 v64, v64, v66
  v_mul_f32 v65, v65, v67
  v_cvt_pk_bf16_f32 v68, v64, v65
  v_lshlrev_b32 v102, 2, v2
  ds_write_b32 v102, v68 offset:2944
  s_mov_b64 exec, -1
  v_lshrrev_b32 v100, 4, v2
  v_bfe_u32 v101, v2, 2, 2
  v_and_b32 v102, 3, v2
  v_lshlrev_b32 v102, 3, v102
  v_lshl_add_u32 v102, v101, 8, v102
  v_lshl_add_u32 v103, v100, 11, v102
  v_lshl_add_u32 v104, v100, 10, v102
  v_add_u32 v103, 71680, v103
  v_add_u32 v104, 71680, v104
  v_and_b32 v105, 1, v101
  v_mul_u32_u24 v105, 96, v105
  v_lshl_add_u32 v106, v100, 4, v105
  v_lshl_add_u32 v107, v100, 3, v105
  v_mov_b32 v108, 3984
L_spin_wd:
  ds_read_b32 v109, v108
  s_waitcnt lgkmcnt(0)
  v_readfirstlane_b32 s87, v109
  s_cmp_ge_u32 s87, 4
  s_cbranch_scc1 L_spun_wd
  s_sleep 1
  s_branch L_spin_wd
L_spun_wd:
  ds_read_b128 v[32:35], v106 offset:2944
  ds_read_b64 v[36:37], v107 offset:3008
  ds_read_b64_tr_b16 v[40:41], v103 offset:0
  ds_read_b64_tr_b16 v[42:43], v103 offset:1024
  ds_read_b64_tr_b16 v[44:45], v104 offset:8192
  ds_read_b64_tr_b16 v[46:47], v103 offset:32
  ds_read_b64_tr_b16 v[48:49], v103 offset:1056
  ds_read_b64_tr_b16 v[50:51], v104 offset:8224
  ds_read_b64_tr_b16 v[52:53], v103 offset:64
  ds_read_b64_tr_b16 v[54:55], v103 offset:1088
  ds_read_b64_tr_b16 v[56:57], v104 offset:8256
  ds_read_b64_tr_b16 v[58:59], v103 offset:96
  ds_read_b64_tr_b16 v[60:61], v103 offset:1120
  ds_read_b64_tr_b16 v[62:63], v104 offset:8288
  ds_read_b64_tr_b16 v[64:65], v103 offset:128
  ds_read_b64_tr_b16 v[66:67], v103 offset:1152
  ds_read_b64_tr_b16 v[68:69], v104 offset:8320
  s_waitcnt lgkmcnt(0)
  v_mfma_f32_16x16x32_bf16 v[72:75], v[32:35], v[40:43], 0
  v_mfma_f32_16x16x32_bf16 v[76:79], v[32:35], v[46:49], 0
  v_mfma_f32_16x16x32_bf16 v[80:83], v[32:35], v[52:55], 0
  v_mfma_f32_16x16x32_bf16 v[84:87], v[32:35], v[58:61], 0
  v_mfma_f32_16x16x32_bf16 v[88:91], v[32:35], v[64:67], 0
  v_mfma_f32_16x16x16_bf16 v[72:75], v[36:37], v[44:45], v[72:75]
  v_mfma_f32_16x16x16_bf16 v[76:79], v[36:37], v[50:51], v[76:79]
  v_mfma_f32_16x16x16_bf16 v[80:83], v[36:37], v[56:57], v[80:83]
  v_mfma_f32_16x16x16_bf16 v[84:87], v[36:37], v[62:63], v[84:87]
  v_mfma_f32_16x16x16_bf16 v[88:91], v[36:37], v[68:69], v[88:91]
  v_and_b32 v105, 15, v2
  v_mul_u32_u24 v106, 320, v100
  v_lshl_add_u32 v106, v105, 2, v106
  s_lshl_b32 s84, s29, 5
  s_add_u32 s84, s84, s28
  s_mul_i32 s84, s84, 640
  s_add_u32 s84, s84, 1835008
  s_mov_b32 exec_lo, -1
  s_mov_b32 exec_hi, 0
  s_nop 4
  buffer_store_dword v72, v106, s[60:63], s84 offen offset:0 sc1
  buffer_store_dword v76, v106, s[60:63], s84 offen offset:64 sc1
  buffer_store_dword v80, v106, s[60:63], s84 offen offset:128 sc1
  buffer_store_dword v84, v106, s[60:63], s84 offen offset:192 sc1
  buffer_store_dword v88, v106, s[60:63], s84 offen offset:256 sc1
  s_mov_b64 exec, -1
  s_cmp_eq_u32 s28, 0
  s_cbranch_scc0 L_nofinchk
  s_mov_b32 s94, 1048576
  v_lshlrev_b32 v100, 2, v2
  v_and_b32 v101, 15, v2
L_poll2:
  buffer_load_dword v102, v100, s[64:67], 0 offen sc1
  s_waitcnt vmcnt(0)
  v_and_b32 v102, 0xff, v102
  v_cmp_gt_u32 vcc, 8, v102
  v_cmp_gt_u32 s[84:85], 8, v101
  s_nop 1
  s_and_b64 vcc, vcc, s[84:85]
  s_cbranch_vccz L_nofinchk
  s_sleep 8
  s_sub_u32 s94, s94, 1
  s_cmp_lg_u32 s94, 0
  s_cbranch_scc1 L_poll2
L_nofinchk:
  s_waitcnt vmcnt(0)
  s_setprio 0
  v_and_b32 v122, 7, v2
  v_lshlrev_b32 v122, 4, v122
  ds_read_b128 v[68:71], v122 offset:2560
  ds_read_b128 v[72:75], v122 offset:2688
  ds_read_b128 v[76:79], v122 offset:2816
  v_mov_b32 v123, 3996
  ds_read_b32 v124, v123
  s_waitcnt lgkmcnt(0)
  v_readfirstlane_b32 s15, v124
  v_mov_b32 v118, 0xf149f2ca
  v_mov_b32 v119, 0
  v_mov_b32 v80, 0
  v_mov_b32 v81, 0
  v_mov_b32 v82, 0
  v_mov_b32 v83, 0
  v_mov_b32 v84, 0
  v_mov_b32 v85, 0
  v_mov_b32 v86, 0
  v_mov_b32 v87, 0
  v_mov_b32 v88, 0
  v_mov_b32 v89, 0
  v_mov_b32 v90, 0
  v_mov_b32 v91, 0
  v_mov_b32 v92, 0
  v_mov_b32 v93, 0
  v_mov_b32 v94, 0
  v_mov_b32 v95, 0
  v_mov_b32 v96, 0
  v_mov_b32 v97, 0
  v_mov_b32 v98, 0
  v_mov_b32 v99, 0
  v_mov_b32 v100, 0
  v_mov_b32 v101, 0
  v_mov_b32 v102, 0
  v_mov_b32 v103, 0
  v_mov_b32 v121, 3992
  v_mov_b32 v126, 1
  s_mov_b64 exec, 1
  ds_add_rtn_u32 v121, v121, v126
  s_mov_b64 exec, -1
  s_waitcnt lgkmcnt(0)
  s_waitcnt vmcnt(0)
  s_branch L_dyn_got
L_dyn:
  s_cmp_ge_u32 s100, s90
  s_cbranch_scc1 L_tail
  s_mul_i32 s101, s100, 3072
  s_add_u32 s101, s101, s91
  buffer_load_dwordx4 v[56:59], v1, s[32:35], s101 offen offset:0 nt
  buffer_load_dwordx4 v[60:63], v1, s[32:35], s101 offen offset:128 nt
  buffer_load_dwordx4 v[64:67], v1, s[32:35], s101 offen offset:256 nt
  buffer_load_dwordx4 v[8:11], v1, s[36:39], s101 offen offset:0 nt
  buffer_load_dwordx4 v[12:15], v1, s[36:39], s101 offen offset:128 nt
  buffer_load_dwordx4 v[16:19], v1, s[36:39], s101 offen offset:256 nt
L_dyn_mid:
  s_waitcnt vmcnt(3)
  v_mov_b32 v122, 0
  v_dot2c_f32_bf16 v122, v56, v68
  v_dot2c_f32_bf16 v122, v57, v69
  v_dot2c_f32_bf16 v122, v58, v70
  v_dot2c_f32_bf16 v122, v59, v71
  v_dot2c_f32_bf16 v122, v60, v72
  v_dot2c_f32_bf16 v122, v61, v73
  v_dot2c_f32_bf16 v122, v62, v74
  v_dot2c_f32_bf16 v122, v63, v75
  v_dot2c_f32_bf16 v122, v64, v76
  v_dot2c_f32_bf16 v122, v65, v77
  v_dot2c_f32_bf16 v122, v66, v78
  v_dot2c_f32_bf16 v122, v67, v79
  s_nop 1
  s_nop 1
  v_add_f32_dpp v122, v122, v122 quad_perm:[1,0,3,2] row_mask:0xf bank_mask:0xf
  s_nop 1
  v_add_f32_dpp v122, v122, v122 quad_perm:[2,3,0,1] row_mask:0xf bank_mask:0xf
  s_nop 1
  v_add_f32_dpp v122, v122, v122 row_half_mirror row_mask:0xf bank_mask:0xf
  v_cvt_pk_bf16_f32 v122, v122, v122
  v_and_b32 v122, 0xffff0000, v122
  v_mul_f32 v122, 0x3d93cd3a, v122
  v_cvt_pk_bf16_f32 v122, v122, v122
  v_and_b32 v122, 0xffff0000, v122
  v_mul_f32 v123, 0x3fb8aa3b, v122
  v_max_f32 v123, v123, v118
  v_sub_f32 v124, v118, v123
  v_mov_b32 v118, v123
  s_mov_b32 s84, 0x3fb8aa3b
  v_fma_f32 v122, v122, s84, -v118
  v_exp_f32 v124, v124
  v_exp_f32 v122, v122
  s_nop 0
  v_fma_f32 v119, v119, v124, v122
  v_mul_f32 v80, v80, v124
  v_mul_f32 v81, v81, v124
  v_mul_f32 v82, v82, v124
  v_mul_f32 v83, v83, v124
  v_mul_f32 v84, v84, v124
  v_mul_f32 v85, v85, v124
  v_mul_f32 v86, v86, v124
  v_mul_f32 v87, v87, v124
  v_mul_f32 v88, v88, v124
  v_mul_f32 v89, v89, v124
  v_mul_f32 v90, v90, v124
  v_mul_f32 v91, v91, v124
  v_mul_f32 v92, v92, v124
  v_mul_f32 v93, v93, v124
  v_mul_f32 v94, v94, v124
  v_mul_f32 v95, v95, v124
  v_mul_f32 v96, v96, v124
  v_mul_f32 v97, v97, v124
  v_mul_f32 v98, v98, v124
  v_mul_f32 v99, v99, v124
  v_mul_f32 v100, v100, v124
  v_mul_f32 v101, v101, v124
  v_mul_f32 v102, v102, v124
  v_mul_f32 v103, v103, v124
  v_cvt_pk_bf16_f32 v122, v122, v122
  v_and_b32 v123, 0xffff0000, v122
  v_lshrrev_b32 v122, 16, v122
  s_waitcnt vmcnt(0)
  v_dot2c_f32_bf16 v80, v8, v122
  v_dot2c_f32_bf16 v81, v8, v123
  v_dot2c_f32_bf16 v82, v9, v122
  v_dot2c_f32_bf16 v83, v9, v123
  v_dot2c_f32_bf16 v84, v10, v122
  v_dot2c_f32_bf16 v85, v10, v123
  v_dot2c_f32_bf16 v86, v11, v122
  v_dot2c_f32_bf16 v87, v11, v123
  v_dot2c_f32_bf16 v88, v12, v122
  v_dot2c_f32_bf16 v89, v12, v123
  v_dot2c_f32_bf16 v90, v13, v122
  v_dot2c_f32_bf16 v91, v13, v123
  v_dot2c_f32_bf16 v92, v14, v122
  v_dot2c_f32_bf16 v93, v14, v123
  v_dot2c_f32_bf16 v94, v15, v122
  v_dot2c_f32_bf16 v95, v15, v123
  v_dot2c_f32_bf16 v96, v16, v122
  v_dot2c_f32_bf16 v97, v16, v123
  v_dot2c_f32_bf16 v98, v17, v122
  v_dot2c_f32_bf16 v99, v17, v123
  v_dot2c_f32_bf16 v100, v18, v122
  v_dot2c_f32_bf16 v101, v18, v123
  v_dot2c_f32_bf16 v102, v19, v122
  v_dot2c_f32_bf16 v103, v19, v123
  s_cmp_lt_u32 s100, 0
  s_cbranch_scc1 L_dyn_got
  v_mov_b32 v121, 3992
  v_mov_b32 v126, 1
  s_mov_b64 exec, 1
  ds_add_rtn_u32 v121, v121, v126
  s_mov_b64 exec, -1
  s_waitcnt lgkmcnt(0)
L_dyn_got:
  v_readfirstlane_b32 s100, v121
  s_nop 0
  s_sub_u32 s100, s100, 0
  s_branch L_dyn
L_tail:
  s_mov_b32 s82, 99
  v_mov_b32 v13, 3988
  v_mov_b32 v14, 1
  s_mov_b32 s83, 99
  s_cmp_ge_u32 s30, 14
  s_cbranch_scc1 L_norank
  s_mov_b64 exec, 1
  ds_add_rtn_u32 v15, v13, v14
  s_mov_b64 exec, -1
L_norank:
  v_mov_b32 v122, v118
  v_and_b32 v16, 7, v2
  v_lshlrev_b32 v16, 5, v16
  v_max_f32_dpp v122, v122, v122 row_ror:8 row_mask:0xf bank_mask:0xf
  v_lshrrev_b32 v17, 3, v2
  v_mov_b32 v123, v122
  v_lshl_add_u32 v16, v17, 2, v16
  s_mul_i32 s84, s30, 784
  v_permlane16_swap_b32 v122, v123
  v_max_f32 v122, v122, v123
  v_mov_b32 v123, v122
  v_add_u32 v16, s84, v16
  s_lshl_b32 s84, s30, 2
  v_permlane32_swap_b32 v122, v123
  v_max_f32 v122, v122, v123
  v_sub_f32 v120, v118, v122
  v_mov_b32 v118, v122
  v_exp_f32 v120, v120
  v_mov_b32 v17, s84
  v_mul_f32 v119, v119, v120
  v_mul_f32 v80, v80, v120
  v_mul_f32 v81, v81, v120
  v_mul_f32 v82, v82, v120
  v_mul_f32 v83, v83, v120
  v_mul_f32 v84, v84, v120
  v_mul_f32 v85, v85, v120
  v_mul_f32 v86, v86, v120
  v_mul_f32 v87, v87, v120
  v_mul_f32 v88, v88, v120
  v_mul_f32 v89, v89, v120
  v_mul_f32 v90, v90, v120
  v_mul_f32 v91, v91, v120
  v_mul_f32 v92, v92, v120
  v_mul_f32 v93, v93, v120
  v_mul_f32 v94, v94, v120
  v_mul_f32 v95, v95, v120
  v_mul_f32 v96, v96, v120
  v_mul_f32 v97, v97, v120
  v_mul_f32 v98, v98, v120
  v_mul_f32 v99, v99, v120
  v_mul_f32 v100, v100, v120
  v_mul_f32 v101, v101, v120
  v_mul_f32 v102, v102, v120
  v_mul_f32 v103, v103, v120
  v_add_f32_dpp v119, v119, v119 row_ror:8 row_mask:0xf bank_mask:0xf
  v_permlane32_swap_b32 v80, v84
  v_permlane32_swap_b32 v81, v85
  v_permlane32_swap_b32 v82, v86
  v_permlane32_swap_b32 v83, v87
  v_permlane32_swap_b32 v88, v92
  v_permlane32_swap_b32 v89, v93
  v_permlane32_swap_b32 v90, v94
  v_permlane32_swap_b32 v91, v95
  v_permlane32_swap_b32 v96, v100
  v_permlane32_swap_b32 v97, v101
  v_permlane32_swap_b32 v98, v102
  v_permlane32_swap_b32 v99, v103
  v_mov_b32 v123, v119
  v_add_f32 v80, v80, v84
  v_add_f32 v81, v81, v85
  v_add_f32 v82, v82, v86
  v_add_f32 v83, v83, v87
  v_add_f32 v88, v88, v92
  v_add_f32 v89, v89, v93
  v_add_f32 v90, v90, v94
  v_add_f32 v91, v91, v95
  v_add_f32 v96, v96, v100
  v_add_f32 v97, v97, v101
  v_add_f32 v98, v98, v102
  v_add_f32 v99, v99, v103
  v_permlane16_swap_b32 v119, v123
  v_add_f32 v119, v119, v123
  v_permlane16_swap_b32 v80, v82
  v_permlane16_swap_b32 v81, v83
  v_permlane16_swap_b32 v88, v90
  v_permlane16_swap_b32 v89, v91
  v_permlane16_swap_b32 v96, v98
  v_permlane16_swap_b32 v97, v99
  v_mov_b32 v123, v119
  v_add_f32 v80, v80, v82
  v_add_f32 v81, v81, v83
  v_add_f32 v88, v88, v90
  v_add_f32 v89, v89, v91
  v_add_f32 v96, v96, v98
  v_add_f32 v97, v97, v99
  v_permlane32_swap_b32 v119, v123
  v_add_f32 v119, v119, v123
  v_cndmask_b32 v82, v80, v81, s[92:93]
  v_cndmask_b32 v83, v81, v80, s[92:93]
  v_cndmask_b32 v90, v88, v89, s[92:93]
  v_cndmask_b32 v91, v89, v88, s[92:93]
  v_cndmask_b32 v98, v96, v97, s[92:93]
  v_cndmask_b32 v99, v97, v96, s[92:93]
  s_mov_b64 exec, 1
  ds_write_b32 v17, v118 offset:4032
  ds_write_b32 v17, v119 offset:4096
  s_mov_b64 exec, -1
  v_add_f32_dpp v80, v83, v82 row_ror:8 row_mask:0xf bank_mask:0xf
  v_add_f32_dpp v88, v91, v90 row_ror:8 row_mask:0xf bank_mask:0xf
  v_add_f32_dpp v96, v99, v98 row_ror:8 row_mask:0xf bank_mask:0xf
  ds_write_b32 v16, v80 offset:4160
  ds_write_b32 v16, v88 offset:4416
  ds_write_b32 v16, v96 offset:4672
  s_waitcnt lgkmcnt(0)
  s_cmp_ge_u32 s30, 14
  s_cbranch_scc1 L_nowo_issue
  v_readfirstlane_b32 s83, v15
  s_nop 0
  s_sub_u32 s83, s83, 1
  s_cmp_ge_u32 s83, 12
  s_cbranch_scc1 L_nowo_issue
  v_lshrrev_b32 v8, 4, v2
  v_and_b32 v9, 15, v2
  v_lshlrev_b32 v10, 1, v8
  v_sub_u32 v9, v9, v10
  v_and_b32 v9, 15, v9
  v_xor_b32 v10, 8, v9
  v_mul_u32_u24 v8, 1280, v8
  v_lshl_add_u32 v11, v9, 4, v8
  v_lshl_add_u32 v12, v10, 4, v8
  v_cmp_gt_u32 s[86:87], 10, v9
  v_cmp_gt_u32 s[88:89], 10, v10
  s_mov_b32 s84, s83
  s_mul_i32 s85, s84, 4096
  s_mul_i32 s84, s84, 20480
  s_add_u32 s85, s85, 83968
  s_mov_b64 exec, s[86:87]
  s_mov_b32 m0, s85
  s_nop 0
  buffer_load_dwordx4 v11, s[56:59], s84 offen nt lds
  s_add_u32 m0, s85, 1024
  s_add_u32 s84, s84, 5120
  buffer_load_dwordx4 v11, s[56:59], s84 offen nt lds
  s_mov_b64 exec, s[88:89]
  s_add_u32 m0, s85, 2048
  s_add_u32 s84, s84, 5120
  buffer_load_dwordx4 v12, s[56:59], s84 offen nt lds
  s_add_u32 m0, s85, 3072
  s_add_u32 s84, s84, 5120
  buffer_load_dwordx4 v12, s[56:59], s84 offen nt lds
  s_mov_b64 exec, -1
L_nowo_issue:
  s_barrier
  s_lshl_b32 s85, s96, 10
  s_add_u32 s85, s85, 1048576
  s_mul_i32 s84, s15, 262144
  s_add_u32 s85, s85, s84
  s_cmp_ge_u32 s30, 13
  s_cbranch_scc1 L_h1
  v_and_b32 v32, 15, v2
  v_lshlrev_b32 v34, 2, v32
  ds_read_b32 v40, v34 offset:4032
  s_cmp_eq_u32 s30, 12
  s_cbranch_scc1 L_ml
  v_mul_u32_u24 v32, 784, v32
  v_lshrrev_b32 v33, 4, v2
  s_lshl_b32 s84, s30, 2
  v_add_u32 v33, s84, v33
  v_lshlrev_b32 v33, 4, v33
  v_add_u32 v32, v32, v33
  ds_read_b128 v[36:39], v32 offset:4160
  s_waitcnt lgkmcnt(0)
  v_mov_b32 v41, v40
  s_nop 1
  v_max_f32_dpp v41, v41, v41 row_ror:8 row_mask:0xf bank_mask:0xf
  s_nop 1
  v_max_f32_dpp v41, v41, v41 row_ror:4 row_mask:0xf bank_mask:0xf
  s_nop 1
  v_max_f32_dpp v41, v41, v41 row_ror:2 row_mask:0xf bank_mask:0xf
  s_nop 1
  v_max_f32_dpp v41, v41, v41 row_ror:1 row_mask:0xf bank_mask:0xf
  v_sub_f32 v40, v40, v41
  v_exp_f32 v40, v40
  s_nop 0
  v_mul_f32 v36, v36, v40
  v_mul_f32 v37, v37, v40
  v_mul_f32 v38, v38, v40
  v_mul_f32 v39, v39, v40
  s_nop 0
  v_add_f32_dpp v36, v36, v36 row_ror:8 row_mask:0xf bank_mask:0xf
  v_add_f32_dpp v37, v37, v37 row_ror:8 row_mask:0xf bank_mask:0xf
  v_add_f32_dpp v38, v38, v38 row_ror:8 row_mask:0xf bank_mask:0xf
  v_add_f32_dpp v39, v39, v39 row_ror:8 row_mask:0xf bank_mask:0xf
  s_nop 0
  v_add_f32_dpp v36, v36, v36 row_ror:4 row_mask:0xf bank_mask:0xf
  v_add_f32_dpp v37, v37, v37 row_ror:4 row_mask:0xf bank_mask:0xf
  v_add_f32_dpp v38, v38, v38 row_ror:4 row_mask:0xf bank_mask:0xf
  v_add_f32_dpp v39, v39, v39 row_ror:4 row_mask:0xf bank_mask:0xf
  s_nop 0
  v_add_f32_dpp v36, v36, v36 row_ror:2 row_mask:0xf bank_mask:0xf
  v_add_f32_dpp v37, v37, v37 row_ror:2 row_mask:0xf bank_mask:0xf
  v_add_f32_dpp v38, v38, v38 row_ror:2 row_mask:0xf bank_mask:0xf
  v_add_f32_dpp v39, v39, v39 row_ror:2 row_mask:0xf bank_mask:0xf
  s_nop 0
  v_add_f32_dpp v36, v36, v36 row_ror:1 row_mask:0xf bank_mask:0xf
  v_add_f32_dpp v37, v37, v37 row_ror:1 row_mask:0xf bank_mask:0xf
  v_add_f32_dpp v38, v38, v38 row_ror:1 row_mask:0xf bank_mask:0xf
  v_add_f32_dpp v39, v39, v39 row_ror:1 row_mask:0xf bank_mask:0xf
  s_mov_b32 exec_lo, 0x00010001
  s_mov_b32 exec_hi, 0x00010001

  s_cmp_eq_u32 s15, 1
  s_cbranch_scc1 L_fst_a
  buffer_store_dwordx4 v[36:39], v33, s[60:63], s85 offen sc1
  s_branch L_fste_a
L_fst_a:
  buffer_store_dwordx4 v[36:39], v33, s[60:63], s85 offen
L_fste_a:
  s_mov_b64 exec, -1
  s_branch L_h1
L_ml:
  ds_read_b32 v37, v34 offset:4096
  s_waitcnt lgkmcnt(0)
  v_mov_b32 v36, v40
  s_nop 1
  v_max_f32_dpp v36, v36, v36 row_ror:8 row_mask:0xf bank_mask:0xf
  s_nop 1
  v_max_f32_dpp v36, v36, v36 row_ror:4 row_mask:0xf bank_mask:0xf
  s_nop 1
  v_max_f32_dpp v36, v36, v36 row_ror:2 row_mask:0xf bank_mask:0xf
  s_nop 1
  v_max_f32_dpp v36, v36, v36 row_ror:1 row_mask:0xf bank_mask:0xf
  v_sub_f32 v40, v40, v36
  v_exp_f32 v40, v40
  s_nop 0
  v_mul_f32 v37, v37, v40
  s_nop 1
  v_add_f32_dpp v37, v37, v37 row_ror:8 row_mask:0xf bank_mask:0xf
  s_nop 1
  v_add_f32_dpp v37, v37, v37 row_ror:4 row_mask:0xf bank_mask:0xf
  s_nop 1
  v_add_f32_dpp v37, v37, v37 row_ror:2 row_mask:0xf bank_mask:0xf
  s_nop 1
  v_add_f32_dpp v37, v37, v37 row_ror:1 row_mask:0xf bank_mask:0xf
  v_mov_b32 v38, 0
  v_mov_b32 v39, 0
  v_mov_b32 v33, 768
  s_mov_b64 exec, 1

  s_cmp_eq_u32 s15, 1
  s_cbranch_scc1 L_fst_b
  buffer_store_dwordx4 v[36:39], v33, s[60:63], s85 offen sc1
  s_branch L_fste_b
L_fst_b:
  buffer_store_dwordx4 v[36:39], v33, s[60:63], s85 offen
L_fste_b:
  s_mov_b64 exec, -1
L_h1:
  v_lshrrev_b32 v110, 2, v0
  v_cmp_le_u32 vcc, 80, v110
  v_mov_b32 v111, 0
  v_mov_b32 v112, 1120
  v_cndmask_b32 v111, v111, v112, vcc
  v_lshl_add_u32 v111, v110, 1, v111
  s_mul_i32 s89, s29, 160
  v_add_u32 v111, s89, v111
  s_cmp_eq_u32 s28, 0
  s_cbranch_scc0 L_nox
  buffer_load_ushort v113, v111, s[68:71], 0 offen
L_nox:
  s_cmp_ge_u32 s83, 12
  s_cbranch_scc1 L_nowo
  s_waitcnt vmcnt(0)
  v_mov_b32 v100, 3976
  v_mov_b32 v101, 1
  s_mov_b64 exec, 1
  ds_add_u32 v100, v101
  s_mov_b64 exec, -1
L_nowo:
  s_cmp_lt_u32 s30, 14
  s_cbranch_scc1 L_h1_skip
  s_sub_u32 s89, s30, 14
  s_lshl_b32 s84, s28, 3
  s_lshl_b32 s85, s89, 2
  s_mul_i32 s85, s85, 1
  s_add_u32 s84, s84, s85
  s_lshl_b32 s84, s84, 10
  s_add_u32 s84, s84, 1048576
  s_mul_i32 s88, s15, 262144
  s_add_u32 s84, s84, s88
  s_add_u32 s85, s84, 1024
  s_add_u32 s86, s84, 2048
  s_add_u32 s87, s84, 3072
  s_nop 0
  v_lshlrev_b32 v32, 4, v2
  s_mov_b32 exec_lo, -1
  s_mov_b32 exec_hi, 0xffff
  s_mov_b32 s94, 1048576
L_poll3:
  buffer_load_dwordx4 v[36:39], v32, s[60:63], s84 offen sc1
  buffer_load_dwordx2 v[52:53], off, s[60:63], s84 offset:768 sc1
  buffer_load_dwordx4 v[40:43], v32, s[60:63], s85 offen sc1
  buffer_load_dwordx2 v[54:55], off, s[60:63], s85 offset:768 sc1
  buffer_load_dwordx4 v[44:47], v32, s[60:63], s86 offen sc1
  buffer_load_dwordx2 v[56:57], off, s[60:63], s86 offset:768 sc1
  buffer_load_dwordx4 v[48:51], v32, s[60:63], s87 offen sc1
  buffer_load_dwordx2 v[58:59], off, s[60:63], s87 offset:768 sc1
  s_waitcnt vmcnt(0)
  v_max3_u32 v60, v36, v37, v38
  v_max3_u32 v60, v60, v39, v40
  v_max3_u32 v60, v60, v41, v42
  v_max3_u32 v60, v60, v43, v44
  v_max3_u32 v60, v60, v45, v46
  v_max3_u32 v60, v60, v47, v48
  v_max3_u32 v60, v60, v49, v50
  v_max3_u32 v60, v60, v51, v52
  v_max3_u32 v60, v60, v53, v54
  v_max3_u32 v60, v60, v55, v56
  v_max3_u32 v60, v60, v57, v58
  v_max_u32 v60, v60, v59
  v_cmp_eq_u32 vcc, -1, v60
  s_cbranch_vccz L_poll3_ok
  s_sub_u32 s94, s94, 1
  s_cmp_lg_u32 s94, 0
  s_cbranch_scc1 L_poll3
L_poll3_ok:
  v_max3_f32 v60, v52, v54, v56
  v_max_f32 v60, v60, v58
  v_sub_f32 v52, v52, v60
  v_sub_f32 v54, v54, v60
  v_sub_f32 v56, v56, v60
  v_sub_f32 v58, v58, v60
  v_exp_f32 v52, v52
  v_exp_f32 v54, v54
  v_exp_f32 v56, v56
  v_exp_f32 v58, v58
  s_nop 0
  v_mul_f32 v61, v52, v53
  v_fmac_f32 v61, v54, v55
  v_fmac_f32 v61, v56, v57
  v_fmac_f32 v61, v58, v59
  v_rcp_f32 v61, v61
  s_nop 0
  v_mul_f32 v52, v52, v61
  v_mul_f32 v54, v54, v61
  v_mul_f32 v56, v56, v61
  v_mul_f32 v58, v58, v61
  v_mul_f32 v36, v36, v52
  v_mul_f32 v37, v37, v52
  v_mul_f32 v38, v38, v52
  v_mul_f32 v39, v39, v52
  v_fmac_f32 v36, v40, v54
  v_fmac_f32 v37, v41, v54
  v_fmac_f32 v38, v42, v54
  v_fmac_f32 v39, v43, v54
  v_fmac_f32 v36, v44, v56
  v_fmac_f32 v37, v45, v56
  v_fmac_f32 v38, v46, v56
  v_fmac_f32 v39, v47, v56
  v_fmac_f32 v36, v48, v58
  v_fmac_f32 v37, v49, v58
  v_fmac_f32 v38, v50, v58
  v_fmac_f32 v39, v51, v58
  v_cvt_pk_bf16_f32 v40, v36, v37
  v_cvt_pk_bf16_f32 v41, v38, v39
  s_mul_i32 s84, s89, 384
  v_lshlrev_b32 v32, 3, v2
  v_add_u32 v32, s84, v32
  ds_write_b64 v32, v[40:41] offset:3200
  s_mov_b64 exec, -1
  s_branch L_h1_done
L_h1_skip:
  s_sub_u32 s82, s30, 6
  s_cmp_eq_u32 s30, 1
  s_cselect_b32 s82, 0, s82
  s_cmp_eq_u32 s30, 6
  s_cselect_b32 s82, 99, s82
  s_cmp_eq_u32 s28, 0
  s_cselect_b32 s82, s82, 99
  s_cmp_ge_u32 s82, 8
  s_cbranch_scc1 L_nog
  s_lshl_b32 s84, s29, 5
  s_lshl_b32 s85, s82, 2
  s_add_u32 s84, s84, s85
  s_mul_i32 s84, s84, 640
  s_add_u32 s84, s84, 1835008
  v_lshlrev_b32 v32, 4, v2
  s_mov_b32 exec_lo, -1
  s_mov_b32 exec_hi, 0xff
  s_mov_b32 s94, 1048576
L_pollg2:
  buffer_load_dwordx4 v[52:55], v32, s[60:63], s84 offen offset:0 sc1
  buffer_load_dwordx4 v[56:59], v32, s[60:63], s84 offen offset:640 sc1
  buffer_load_dwordx4 v[60:63], v32, s[60:63], s84 offen offset:1280 sc1
  buffer_load_dwordx4 v[64:67], v32, s[60:63], s84 offen offset:1920 sc1
  s_waitcnt vmcnt(0)
  v_max3_u32 v70, v52, v53, v54
  v_max3_u32 v70, v70, v55, v56
  v_max3_u32 v70, v70, v57, v58
  v_max3_u32 v70, v70, v59, v60
  v_max3_u32 v70, v70, v61, v62
  v_max3_u32 v70, v70, v63, v64
  v_max3_u32 v70, v70, v65, v66
  v_max_u32 v70, v70, v67
  v_cmp_eq_u32 vcc, -1, v70
  s_cbranch_vccz L_pollg2_ok
  s_sub_u32 s94, s94, 1
  s_cmp_lg_u32 s94, 0
  s_cbranch_scc1 L_pollg2
L_pollg2_ok:
  v_add_f32 v52, v52, v56
  v_add_f32 v60, v60, v64
  v_add_f32 v53, v53, v57
  v_add_f32 v61, v61, v65
  v_add_f32 v54, v54, v58
  v_add_f32 v62, v62, v66
  v_add_f32 v55, v55, v59
  v_add_f32 v63, v63, v67
  v_add_f32 v52, v52, v60
  v_add_f32 v53, v53, v61
  v_add_f32 v54, v54, v62
  v_add_f32 v55, v55, v63
  s_mov_b64 exec, -1
  s_branch L_h1_done
L_nog:
  s_sub_u32 s84, s30, 2
  s_cmp_lt_u32 s84, 5
  s_cbranch_scc0 L_h1_done
  v_lshrrev_b32 v100, 4, v2
  v_bfe_u32 v101, v2, 2, 2
  v_and_b32 v102, 3, v2
  v_lshlrev_b32 v102, 3, v102
  v_lshlrev_b32 v103, 3, v100
  v_add_u32 v103, v103, v101
  v_lshlrev_b32 v103, 8, v103
  v_and_b32 v104, 1, v100
  v_lshlrev_b32 v104, 2, v104
  v_add_u32 v104, v104, v101
  v_add_u32 v104, s84, v104
  v_and_b32 v104, 7, v104
  v_lshlrev_b32 v104, 5, v104
  v_add_u32 v103, v103, v104
  v_add_u32 v103, v103, v102
  v_add_u32 v103, 83968, v103
  v_and_b32 v105, 1, v101
  v_mul_u32_u24 v105, 384, v105
  v_lshl_add_u32 v105, v100, 4, v105
  v_mov_b32 v106, 3976
L_spin_wo:
  ds_read_b32 v107, v106
  s_waitcnt lgkmcnt(0)
  v_readfirstlane_b32 s87, v107
  s_cmp_ge_u32 s87, 12
  s_cbranch_scc1 L_spun_wo
  s_sleep 1
  s_branch L_spin_wo
L_spun_wo:
  ds_read_b64_tr_b16 v[32:33], v103 offset:0
  ds_read_b64_tr_b16 v[34:35], v103 offset:1024
  ds_read_b64_tr_b16 v[36:37], v103 offset:8192
  ds_read_b64_tr_b16 v[38:39], v103 offset:9216
  ds_read_b64_tr_b16 v[40:41], v103 offset:16384
  ds_read_b64_tr_b16 v[42:43], v103 offset:17408
  ds_read_b64_tr_b16 v[44:45], v103 offset:24576
  ds_read_b64_tr_b16 v[46:47], v103 offset:25600
  ds_read_b64_tr_b16 v[48:49], v103 offset:32768
  ds_read_b64_tr_b16 v[50:51], v103 offset:33792
  ds_read_b64_tr_b16 v[52:53], v103 offset:40960
  ds_read_b64_tr_b16 v[54:55], v103 offset:41984
L_h1_done:
  s_waitcnt vmcnt(0) lgkmcnt(0)
  s_barrier
  s_sub_u32 s84, s30, 2
  s_cmp_lt_u32 s84, 5
  s_cbranch_scc0 L_t3_done
  ds_read_b128 v[8:11], v105 offset:3200
  ds_read_b128 v[12:15], v105 offset:3264
  ds_read_b128 v[16:19], v105 offset:3328
  ds_read_b128 v[20:23], v105 offset:3392
  ds_read_b128 v[24:27], v105 offset:3456
  ds_read_b128 v[28:31], v105 offset:3520
  v_and_b32 v107, 15, v2
  v_mul_u32_u24 v106, 320, v100
  v_lshl_add_u32 v106, v107, 2, v106
  s_lshl_b32 s86, s29, 5
  s_add_u32 s86, s86, s28
  s_mul_i32 s86, s86, 640
  s_lshl_b32 s85, s84, 6
  s_add_u32 s86, s86, s85
  s_add_u32 s86, s86, 1572864
  s_waitcnt lgkmcnt(0)
  v_mfma_f32_16x16x32_bf16 v[60:63], v[8:11], v[32:35], 0
  v_mfma_f32_16x16x32_bf16 v[64:67], v[12:15], v[36:39], 0
  v_mfma_f32_16x16x32_bf16 v[60:63], v[16:19], v[40:43], v[60:63]
  v_mfma_f32_16x16x32_bf16 v[64:67], v[20:23], v[44:47], v[64:67]
  v_mfma_f32_16x16x32_bf16 v[60:63], v[24:27], v[48:51], v[60:63]
  v_mfma_f32_16x16x32_bf16 v[64:67], v[28:31], v[52:55], v[64:67]
  s_nop 7
  v_add_f32 v60, v60, v64
  s_mov_b32 exec_lo, -1
  s_mov_b32 exec_hi, 0
  buffer_store_dword v60, v106, s[60:63], s86 offen sc1
  s_mov_b64 exec, -1
L_t3_done:
  s_cmp_eq_u32 s28, 0
  s_cbranch_scc0 L_fin_end
  s_cmp_ge_u32 s82, 8
  s_cbranch_scc1 L_fin_bar
  s_lshl_b32 s84, s29, 5
  s_lshl_b32 s85, s82, 2
  s_add_u32 s84, s84, s85
  s_mul_i32 s84, s84, 640
  s_add_u32 s84, s84, 1572864
  v_lshlrev_b32 v32, 4, v2
  s_mov_b32 exec_lo, -1
  s_mov_b32 exec_hi, 0xff
  s_mov_b32 s94, 1048576
  buffer_load_dwordx4 v[36:39], v32, s[60:63], s84 offen offset:0 sc1
  buffer_load_dwordx4 v[40:43], v32, s[60:63], s84 offen offset:640 sc1
  buffer_load_dwordx4 v[44:47], v32, s[60:63], s84 offen offset:1280 sc1
  buffer_load_dwordx4 v[48:51], v32, s[60:63], s84 offen offset:1920 sc1
L_poll4:
  buffer_load_dwordx4 v[72:75], v32, s[60:63], s84 offen offset:0 sc1
  buffer_load_dwordx4 v[76:79], v32, s[60:63], s84 offen offset:640 sc1
  buffer_load_dwordx4 v[80:83], v32, s[60:63], s84 offen offset:1280 sc1
  buffer_load_dwordx4 v[84:87], v32, s[60:63], s84 offen offset:1920 sc1
  s_waitcnt vmcnt(4)
  v_max3_u32 v70, v36, v37, v38
  v_max3_u32 v70, v70, v39, v40
  v_max3_u32 v70, v70, v41, v42
  v_max3_u32 v70, v70, v43, v44
  v_max3_u32 v70, v70, v45, v46
  v_max3_u32 v70, v70, v47, v48
  v_max3_u32 v70, v70, v49, v50
  v_max_u32 v70, v70, v51
  v_cmp_eq_u32 vcc, -1, v70
  s_cbranch_vccz L_poll4_okA
  buffer_load_dwordx4 v[36:39], v32, s[60:63], s84 offen offset:0 sc1
  buffer_load_dwordx4 v[40:43], v32, s[60:63], s84 offen offset:640 sc1
  buffer_load_dwordx4 v[44:47], v32, s[60:63], s84 offen offset:1280 sc1
  buffer_load_dwordx4 v[48:51], v32, s[60:63], s84 offen offset:1920 sc1
  s_waitcnt vmcnt(4)
  v_max3_u32 v70, v72, v73, v74
  v_max3_u32 v70, v70, v75, v76
  v_max3_u32 v70, v70, v77, v78
  v_max3_u32 v70, v70, v79, v80
  v_max3_u32 v70, v70, v81, v82
  v_max3_u32 v70, v70, v83, v84
  v_max3_u32 v70, v70, v85, v86
  v_max_u32 v70, v70, v87
  v_cmp_eq_u32 vcc, -1, v70
  s_cbranch_vccz L_poll4_okB
  s_sub_u32 s94, s94, 1
  s_cmp_lg_u32 s94, 0
  s_cbranch_scc1 L_poll4
L_poll4_okB:
  v_add_f32 v72, v72, v76
  v_add_f32 v80, v80, v84
  v_add_f32 v73, v73, v77
  v_add_f32 v81, v81, v85
  v_add_f32 v74, v74, v78
  v_add_f32 v82, v82, v86
  v_add_f32 v75, v75, v79
  v_add_f32 v83, v83, v87
  v_add_f32 v72, v72, v80
  v_add_f32 v73, v73, v81
  v_add_f32 v74, v74, v82
  v_add_f32 v75, v75, v83
  s_mul_i32 s84, s82, 1312
  v_add_u32 v32, s84, v32
  ds_write_b128 v32, v[72:75] offset:20480
  s_branch L_poll4_w
L_poll4_okA:
  v_add_f32 v36, v36, v40
  v_add_f32 v44, v44, v48
  v_add_f32 v37, v37, v41
  v_add_f32 v45, v45, v49
  v_add_f32 v38, v38, v42
  v_add_f32 v46, v46, v50
  v_add_f32 v39, v39, v43
  v_add_f32 v47, v47, v51
  v_add_f32 v36, v36, v44
  v_add_f32 v37, v37, v45
  v_add_f32 v38, v38, v46
  v_add_f32 v39, v39, v47
  s_mul_i32 s84, s82, 1312
  v_add_u32 v32, s84, v32
  ds_write_b128 v32, v[36:39] offset:20480
L_poll4_w:
  ds_write_b128 v32, v[52:55] offset:21120
  s_mov_b64 exec, -1
L_fin_bar:
  s_waitcnt lgkmcnt(0)
  s_barrier
  s_cmp_ge_u32 s30, 10
  s_cbranch_scc1 L_fin_end
  v_and_b32 v100, 3, v2
  v_mul_u32_u24 v100, 1312, v100
  v_lshl_add_u32 v100, v110, 2, v100
  ds_read_b32 v101, v100 offset:20480
  ds_read_b32 v103, v100 offset:21120
  ds_read_b32 v102, v100 offset:25728
  ds_read_b32 v104, v100 offset:26368
  s_waitcnt lgkmcnt(0)
  v_add_f32 v101, v101, v102
  v_add_f32 v103, v103, v104
  s_nop 1
  v_add_f32_dpp v101, v101, v101 quad_perm:[1,0,3,2] row_mask:0xf bank_mask:0xf
  v_add_f32_dpp v103, v103, v103 quad_perm:[1,0,3,2] row_mask:0xf bank_mask:0xf
  s_nop 1
  v_add_f32_dpp v101, v101, v101 quad_perm:[2,3,0,1] row_mask:0xf bank_mask:0xf
  v_add_f32_dpp v103, v103, v103 quad_perm:[2,3,0,1] row_mask:0xf bank_mask:0xf
  v_cvt_pk_bf16_f32 v101, v101, v103
  v_and_b32 v103, 0xffff0000, v101
  v_lshlrev_b32 v101, 16, v101
  v_mul_f32 v104, 0xbfb8aa3b, v103
  v_exp_f32 v104, v104
  s_nop 0
  v_add_f32 v104, 1.0, v104
  v_rcp_f32 v104, v104
  s_nop 0
  v_mul_f32 v103, v103, v104
  v_cvt_pk_bf16_f32 v103, v103, v103
  v_and_b32 v103, 0xffff0000, v103
  v_mul_f32 v101, v101, v103
  v_cvt_pk_bf16_f32 v101, v101, v101
  v_and_b32 v101, 0xffff0000, v101
  v_lshlrev_b32 v113, 16, v113
  v_add_f32 v101, v113, v101
  v_cvt_pk_bf16_f32 v101, v101, v101
  s_mov_b32 exec_lo, 0x11111111
  s_mov_b32 exec_hi, 0x11111111
  buffer_store_short v101, v111, s[72:75], 0 offen
L_fin_end:
L_end:
  s_endpgm
L_code_end:
.section .rodata,"a"
.p2align 6
.amdhsa_kernel recurrent_scan__mha_block_cached__geglu_ffn__decode_kernel
  .amdhsa_next_free_vgpr 128
  .amdhsa_next_free_sgpr 102
  .amdhsa_accum_offset 128
  .amdhsa_group_segment_fixed_size 0
  .amdhsa_kernarg_size 96
  .amdhsa_user_sgpr_count 2
  .amdhsa_user_sgpr_kernarg_segment_ptr 1
  .amdhsa_system_sgpr_workgroup_id_x 1
.end_amdhsa_kernel
```
